```python
import torch

def _softmax(x, axis=-1):
    return torch.softmax(x, dim=axis)
def _gelu(x):
    return torch.nn.functional.gelu(x, approximate="tanh")
def _silu(x):
    return torch.nn.functional.silu(x)
def _sigmoid(x):
    return torch.sigmoid(x)
def _layernorm(x, axis=-1, eps=1e-5):
    m = x.mean(dim=axis, keepdim=True)
    v = x.var(dim=axis, keepdim=True, unbiased=False)
    return (x - m) / torch.sqrt(v + eps)
def _scatter_add(tgt, idx, src, axis=0):
    return tgt.clone().index_add_(axis, idx, src)
def _segment_sum(src, seg, n):
    out = torch.zeros((n,) + src.shape[1:], dtype=src.dtype)
    return out.index_add_(0, seg, src)
def _pad(x, pw):
    flat = tuple(v for pair in reversed(pw) for v in pair)
    return torch.nn.functional.pad(x, flat)

kernel_name = 'standalone__edge_featured_mpnn_egc__graph'

def setup_inputs():

    _w = (lambda a: (lambda t: t.to(torch.bfloat16) if t.is_floating_point() else t)(torch.as_tensor(a)))
    N, deg, D, De = 25000, 32, 64, max(4, 1)
    E = N * deg
    return {
        "x": _w((lambda *s: torch.randn(*s, dtype=torch.bfloat16) * 0.2)(N, D)),
        "e_attr": _w((lambda *s: torch.randn(*s, dtype=torch.bfloat16) * 0.2)(E, De)),
        "src": _w((lambda lo, hi, *s: torch.randint(lo, hi, s))(0, N, E).to(torch.int64)),
        "dst": _w((lambda lo, hi, *s: torch.randint(lo, hi, s))(0, N, E).to(torch.int64)),
        "u_w": _w((lambda *s: torch.randn(*s, dtype=torch.bfloat16) * 0.05)(D, D)),
        "v_w": _w((lambda *s: torch.randn(*s, dtype=torch.bfloat16) * 0.05)(D, D)),
        "g_w": _w((lambda *s: torch.randn(*s, dtype=torch.bfloat16) * 0.2)(2 * D + De, D)),
    }

def reference(x, e_attr, src, dst, u_w, v_w, g_w):
    N, D = x.shape
    g_in = torch.concatenate([x[dst], x[src], e_attr], axis=-1)
    eta = _sigmoid(g_in @ g_w)
    hv = x @ v_w
    msg = eta * hv[src]
    agg = _segment_sum(msg, dst, N)
    return _silu(x @ u_w + agg)
```

```asm
; @launch grid=(256,1,1) block=(512,1,1) lds=151168
.amdgcn_target "amdgcn-amd-amdhsa--gfx950"
.text
.globl standalone__edge_featured_mpnn_egc__graph_kernel
.p2align 8
.type standalone__edge_featured_mpnn_egc__graph_kernel,@function
standalone__edge_featured_mpnn_egc__graph_kernel:
    s_load_dwordx16 s[48:63], s[0:1], 0
    s_load_dwordx4 s[64:67], s[0:1], 64
    s_cmp_ge_u32 s2, 256
    s_cbranch_scc1 K2_END
    v_lshrrev_b32 v1, 6, v0
    v_and_b32 v36, 63, v0
    v_readfirstlane_b32 s20, v1
    s_nop 0
    s_cmp_lg_u32 s20, 7
    s_cbranch_scc1 K2_L0
    s_getpc_b64 s[42:43]
    v_lshlrev_b32 v2, 7, v36
    v_add_u32 v3, 8192, v2
    s_and_b32 s42, s42, 0xffffff00
    global_load_dword v254, v2, s[42:43]
    s_mov_b32 exec_hi, 0
    global_load_dword v255, v3, s[42:43]
    s_mov_b32 exec_hi, -1
K2_L0:
    v_lshlrev_b32 v1, 2, v0
    v_add_u32 v1, 148992, v1
    v_mov_b32 v2, 0
    ds_write_b32 v1, v2
    v_lshlrev_b32 v3, 3, v0
    v_lshlrev_b32 v4, 4, v0
    v_add_u32 v5, 6400, v3
    v_add_u32 v6, 6400, v4
    v_add_u32 v7, 12800, v4
    v_add_u32 v8, 19200, v4
    s_mul_i32 s46, s2, 12800
    s_mul_i32 s47, s2, 25600
    s_movk_i32 s40, 400
    s_cmp_lt_u32 s2, 250
    s_cselect_b32 s23, 1, 0
    s_cselect_b32 s40, s40, 0
    v_cmp_gt_u32 s[68:69], s40, v0
    s_and_b32 s21, s20, 3
    s_lshr_b32 s22, s20, 2
    s_lshl_b32 s29, s20, 12
    s_add_u32 s29, s29, 67072
    s_mov_b32 s24, 0
    s_waitcnt lgkmcnt(0)
    s_add_u32 s54, s54, s46
    s_addc_u32 s55, s55, 0
    s_mov_b64 exec, s[68:69]
    s_cbranch_execz K2_L2
    global_load_dwordx2 v[64:65], v3, s[54:55] nt
    global_load_dwordx2 v[66:67], v3, s[54:55] offset:3200 nt
    global_load_dwordx2 v[68:69], v5, s[54:55] nt
    global_load_dwordx2 v[70:71], v5, s[54:55] offset:3200 nt
    s_add_u32 s52, s52, s46
    s_addc_u32 s53, s53, 0
    s_add_u32 s50, s50, s47
    s_addc_u32 s51, s51, 0
    s_barrier
    global_load_dwordx2 v[72:73], v3, s[52:53] nt
    global_load_dwordx2 v[74:75], v3, s[52:53] offset:3200 nt
    global_load_dwordx2 v[76:77], v5, s[52:53] nt
    global_load_dwordx2 v[78:79], v5, s[52:53] offset:3200 nt
    global_load_dwordx4 v[80:83], v4, s[50:51] nt
    global_load_dwordx4 v[84:87], v6, s[50:51] nt
    global_load_dwordx4 v[88:91], v7, s[50:51] nt
    global_load_dwordx4 v[92:95], v8, s[50:51] nt
    s_branch K2_L3
K2_L2:
    s_mov_b64 exec, -1
    s_cmp_lg_u32 s20, 7
    s_cbranch_scc1 K2_L3
    s_cmp_eq_u32 s23, 0
    s_cbranch_scc1 K2_L3
    s_barrier
    s_cmp_lg_u32 s2, 0
    s_cbranch_scc1 K2_L3
    s_memrealtime s[42:43]
    v_and_b32 v2, 15, v36
    v_lshlrev_b32 v2, 3, v2
    s_waitcnt lgkmcnt(0)
    s_or_b32 s43, s43, 0x80000000
    v_mov_b32 v10, s42
    v_mov_b32 v11, s43
    global_store_dwordx2 v2, v[10:11], s[64:65] offset:128 sc0 sc1
K2_L3:
    s_mov_b64 exec, -1

K2_START:
    s_cmp_eq_u32 s24, 0
    s_cselect_b32 s86, 0xbfb8aa3b, 1.0
    s_mov_b32 s87, s86
    s_add_u32 s70, s60, 8192
    s_addc_u32 s71, s61, 0
    s_cmp_eq_u32 s22, 0
    s_cselect_b32 s58, s70, s58
    s_cselect_b32 s59, s71, s59
    s_cselect_b32 s56, s60, s56
    s_cselect_b32 s57, s61, s57
    s_cselect_b32 s70, s86, 1.0
    s_mov_b32 s84, 1
    s_mov_b32 s30, 0xbfb8aa3b
    s_mov_b32 s31, 0xbfb8aa3b
    s_mov_b32 s32, 1.0
    s_mov_b32 s33, 1.0
    s_and_b32 s38, s2, 7
    s_lshl_b32 s38, s38, 5
    s_lshr_b32 s37, s2, 3
    s_or_b32 s37, s37, s38
    s_mov_b32 s16, s66
    s_mov_b32 s17, s67
    s_mov_b32 s18, 10648576
    s_mov_b32 s19, 0x00020000
    s_mov_b32 s8, s48
    s_or_b32 s9, s49, 0x00800000
    s_mov_b32 s10, 25000
    s_mov_b32 s11, 0x00020000
    s_mov_b32 s4, s48
    s_or_b32 s5, s49, 0x00800000
    s_mov_b32 s6, 25000
    s_mov_b32 s7, 0x00020000
    s_mov_b32 s12, s62
    s_or_b32 s13, s63, 0x00800000
    s_mov_b32 s14, 25000
    s_mov_b32 s15, 0x00020000
    s_mov_b32 s25, 0
    s_mov_b32 s26, 32
    v_mov_b32 v37, 0
    v_lshlrev_b32 v120, 4, v36
    s_lshl_b32 s38, s21, 11
    v_add_u32 v28, s38, v120
    v_and_b32 v41, 31, v36
    v_lshlrev_b32 v29, 2, v41
    v_add_u32 v27, 16384, v29
    v_lshlrev_b32 v41, 3, v41
    v_and_b32 v1, 1, v36
    v_bfe_u32 v2, v36, 1, 1
    v_bfe_u32 v3, v36, 2, 1
    v_bfe_u32 v4, v36, 3, 1
    v_bfe_u32 v5, v36, 4, 1
    v_lshrrev_b32 v34, 5, v36
    v_lshl_or_b32 v35, v3, 1, v1
    v_lshl_or_b32 v6, v4, 1, v2
    v_lshl_or_b32 v6, v5, 2, v6
    v_lshl_or_b32 v61, v35, 3, v6
    v_lshlrev_b32 v61, 7, v61
    v_xor_b32 v4, v4, v34
    v_lshl_or_b32 v4, v35, 1, v4
    v_lshl_or_b32 v61, v4, 4, v61
    v_lshl_or_b32 v62, v35, 8, v6
    v_lshlrev_b32 v62, 3, v62
    v_and_b32 v7, 7, v36
    v_xor_b32 v60, v7, v5
    v_lshl_add_u32 v121, v34, 10, v29
    v_add_u32 v121, s29, v121
    v_add_u32 v122, s29, v120
    v_add_u32 v32, 67072, v120
    s_lshl_b32 s40, s22, 14
    v_add_u32 v33, s40, v32
    v_add_u32 v1, 148992, v120
    v_mov_b32 v9, 1
    s_mov_b32 s38, 0x050c0100
    s_cmp_eq_u32 s23, 0
    s_cbranch_scc1 K2_NP1A
    s_mov_b64 exec, s[68:69]
    s_waitcnt vmcnt(8)

    v_and_b32 v96, 255, v64
    v_lshlrev_b32 v96, 2, v96
    v_add_u32 v96, 148992, v96
    ds_add_rtn_u32 v104, v96, v9
    v_and_b32 v97, 255, v65
    v_lshlrev_b32 v97, 2, v97
    v_add_u32 v97, 148992, v97
    ds_add_rtn_u32 v105, v97, v9
    v_and_b32 v98, 255, v66
    v_lshlrev_b32 v98, 2, v98
    v_add_u32 v98, 148992, v98
    ds_add_rtn_u32 v106, v98, v9
    v_and_b32 v99, 255, v67
    v_lshlrev_b32 v99, 2, v99
    v_add_u32 v99, 148992, v99
    ds_add_rtn_u32 v107, v99, v9
    v_and_b32 v100, 255, v68
    v_lshlrev_b32 v100, 2, v100
    v_add_u32 v100, 148992, v100
    ds_add_rtn_u32 v108, v100, v9
    v_and_b32 v101, 255, v69
    v_lshlrev_b32 v101, 2, v101
    v_add_u32 v101, 148992, v101
    ds_add_rtn_u32 v109, v101, v9
    v_and_b32 v102, 255, v70
    v_lshlrev_b32 v102, 2, v102
    v_add_u32 v102, 148992, v102
    ds_add_rtn_u32 v110, v102, v9
    v_and_b32 v103, 255, v71
    v_lshlrev_b32 v103, 2, v103
    v_add_u32 v103, 148992, v103
    ds_add_rtn_u32 v111, v103, v9
    s_mov_b64 exec, -1
    s_waitcnt lgkmcnt(0)
    s_barrier

    ds_read_b128 v[12:15], v1
    s_waitcnt lgkmcnt(0)
    v_add_u32 v16, v12, v13
    v_add_u32 v17, v16, v14
    v_add_u32 v18, v17, v15
    v_mov_b32 v19, v18

    s_nop 1
    v_add_u32_dpp v19, v19, v19 row_shr:1 row_mask:0xf bank_mask:0xf
    s_nop 1
    v_add_u32_dpp v19, v19, v19 row_shr:2 row_mask:0xf bank_mask:0xf
    s_nop 1
    v_add_u32_dpp v19, v19, v19 row_shr:4 row_mask:0xf bank_mask:0xf
    s_nop 1
    v_add_u32_dpp v19, v19, v19 row_shr:8 row_mask:0xf bank_mask:0xf
    s_nop 1
    v_add_u32_dpp v19, v19, v19 row_bcast:15 row_mask:0xa bank_mask:0xf
    s_nop 1
    v_add_u32_dpp v19, v19, v19 row_bcast:31 row_mask:0xc bank_mask:0xf
    v_sub_u32 v20, v19, v18
    v_add_u32 v21, v20, v12
    v_add_u32 v22, v20, v16
    v_add_u32 v23, v20, v17
    s_mov_b32 s39, 99840
    v_mad_u32_u24 v124, v20, 12, s39
    v_mad_u32_u24 v125, v21, 12, s39
    v_mad_u32_u24 v126, v22, 12, s39
    v_mad_u32_u24 v127, v23, 12, s39
    ds_write_b128 v1, v[124:127] offset:1024
    s_mov_b64 exec, s[68:69]

    ds_read_b32 v96, v96 offset:1024
    ds_read_b32 v97, v97 offset:1024
    ds_read_b32 v98, v98 offset:1024
    ds_read_b32 v99, v99 offset:1024
    ds_read_b32 v100, v100 offset:1024
    ds_read_b32 v101, v101 offset:1024
    ds_read_b32 v102, v102 offset:1024
    ds_read_b32 v103, v103 offset:1024
    s_mov_b64 exec, -1
    v_lshl_or_b32 v112, v12, 12, v20
    v_lshl_or_b32 v114, v13, 12, v21
    v_lshl_or_b32 v116, v14, 12, v22
    v_lshl_or_b32 v118, v15, 12, v23
    s_mov_b64 exec, s[68:69]
    s_waitcnt vmcnt(4)

    v_perm_b32 v72, v64, v72, s38
    v_perm_b32 v73, v65, v73, s38
    v_perm_b32 v74, v66, v74, s38
    v_perm_b32 v75, v67, v75, s38
    v_perm_b32 v76, v68, v76, s38
    v_perm_b32 v77, v69, v77, s38
    v_perm_b32 v78, v70, v78, s38
    v_perm_b32 v79, v71, v79, s38
    s_waitcnt lgkmcnt(0)
    v_mad_u32_u24 v96, v104, 12, v96
    v_mad_u32_u24 v97, v105, 12, v97
    v_mad_u32_u24 v98, v106, 12, v98
    v_mad_u32_u24 v99, v107, 12, v99
    v_mad_u32_u24 v100, v108, 12, v100
    v_mad_u32_u24 v101, v109, 12, v101
    v_mad_u32_u24 v102, v110, 12, v102
    v_mad_u32_u24 v103, v111, 12, v103
    ds_write_b32 v96, v72 offset:8
    ds_write_b32 v97, v73 offset:8
    ds_write_b32 v98, v74 offset:8
    ds_write_b32 v99, v75 offset:8
    ds_write_b32 v100, v76 offset:8
    ds_write_b32 v101, v77 offset:8
    ds_write_b32 v102, v78 offset:8
    ds_write_b32 v103, v79 offset:8
    s_waitcnt vmcnt(3)
    ds_write2_b32 v96, v80, v81 offset0:0 offset1:1
    ds_write2_b32 v97, v82, v83 offset0:0 offset1:1
    s_waitcnt vmcnt(2)
    ds_write2_b32 v98, v84, v85 offset0:0 offset1:1
    ds_write2_b32 v99, v86, v87 offset0:0 offset1:1
    s_waitcnt vmcnt(1)
    ds_write2_b32 v100, v88, v89 offset0:0 offset1:1
    ds_write2_b32 v101, v90, v91 offset0:0 offset1:1
    s_waitcnt vmcnt(0)
    ds_write2_b32 v102, v92, v93 offset0:0 offset1:1
    ds_write2_b32 v103, v94, v95 offset0:0 offset1:1
    s_mov_b64 exec, -1
K2_NP1A:
    s_cmp_lg_u32 s20, 7
    s_cbranch_scc1 K2_TAGR
    s_and_b32 s38, s2, 0x78
    v_mov_b32 v2, s38
    s_mov_b32 s38, 0
K2_TAGP:
    global_load_dwordx2 v[30:31], v2, s[64:65] offset:128 sc1
    s_add_u32 s38, s38, 1
    s_waitcnt vmcnt(0)
    v_readfirstlane_b32 s39, v31
    s_cmp_gt_u32 s38, 200000
    s_cbranch_scc1 K2_TAGD
    s_cmp_eq_u32 s39, 0
    s_cbranch_scc1 K2_TAGP
K2_TAGD:
    v_mov_b32 v2, 151104
    ds_write_b64 v2, v[30:31] offset:8
K2_TAGR:

    s_mov_b32 m0, s29
    s_mul_i32 s38, s2, 38400
    global_load_lds_dwordx4 v28, s[58:59]
    global_load_lds_dwordx4 v28, s[58:59] offset:1024
    s_add_u32 m0, s29, 2048
    s_add_u32 s38, s38, 1048576
    global_load_lds_dwordx4 v28, s[56:57]
    global_load_lds_dwordx4 v28, s[56:57] offset:1024

    global_load_dword v216, v27, s[60:61] offset:0
    global_load_dword v217, v27, s[60:61] offset:128
    global_load_dword v218, v27, s[60:61] offset:256
    global_load_dword v219, v27, s[60:61] offset:384
    s_movk_i32 s40, 480
    v_lshlrev_b32 v10, 4, v0
    v_add_u32 v11, 99840, v10
    v_cmp_gt_u32 vcc, s40, v0
    v_lshlrev_b32 v8, 5, v36
    v_lshlrev_b32 v9, 24, v31

    v_or_b32 v112, v112, v9
    v_mov_b32 v113, v30
    v_or_b32 v114, v114, v9
    v_mov_b32 v115, v30
    v_or_b32 v116, v116, v9
    v_mov_b32 v117, v30
    v_or_b32 v118, v118, v9
    v_mov_b32 v119, v30
    s_cmp_eq_u32 s23, 0
    s_cbranch_scc1 K2_NP1B
    s_waitcnt lgkmcnt(0)
    s_barrier

    s_mov_b64 exec, vcc
    ds_read_b128 v[64:67], v11 offset:0
    ds_read_b128 v[68:71], v11 offset:7680
    ds_read_b128 v[72:75], v11 offset:15360
    ds_read_b128 v[76:79], v11 offset:23040
    ds_read_b128 v[80:83], v11 offset:30720
    s_waitcnt lgkmcnt(4)
    buffer_store_dwordx4 v[64:67], v10, s[16:19], s38 offen sc1
    s_add_u32 s38, s38, 7680
    s_waitcnt lgkmcnt(3)
    buffer_store_dwordx4 v[68:71], v10, s[16:19], s38 offen sc1
    s_add_u32 s38, s38, 7680
    s_waitcnt lgkmcnt(2)
    buffer_store_dwordx4 v[72:75], v10, s[16:19], s38 offen sc1
    s_add_u32 s38, s38, 7680
    s_waitcnt lgkmcnt(1)
    buffer_store_dwordx4 v[76:79], v10, s[16:19], s38 offen sc1
    s_add_u32 s38, s38, 7680
    s_waitcnt lgkmcnt(0)
    buffer_store_dwordx4 v[80:83], v10, s[16:19], s38 offen sc1
    s_mov_b64 exec, -1
    s_waitcnt vmcnt(5)
K2_FRAG:

    s_mov_b32 s38, 0x05040100
    s_mov_b32 s39, 0x07060302

    ds_read2_b32 v[200:201], v121 offset0:0 offset1:32
    ds_read2_b32 v[202:203], v121 offset0:64 offset1:96
    ds_read2_b32 v[204:205], v121 offset0:128 offset1:160
    ds_read2_b32 v[206:207], v121 offset0:192 offset1:224
    v_add_u32 v121, 2048, v121
    ds_read2_b32 v[208:209], v121 offset0:0 offset1:32
    ds_read2_b32 v[210:211], v121 offset0:64 offset1:96
    ds_read2_b32 v[212:213], v121 offset0:128 offset1:160
    ds_read2_b32 v[214:215], v121 offset0:192 offset1:224
    v_cmp_gt_u32 vcc, 32, v36
    v_lshlrev_b32 v10, 16, v216
    v_and_b32 v14, 0xffff0000, v216
    v_mul_f32 v10, s86, v10
    v_mul_f32 v14, s86, v14
    v_lshlrev_b32 v11, 16, v217
    v_and_b32 v15, 0xffff0000, v217
    v_mul_f32 v11, s86, v11
    v_mul_f32 v15, s86, v15
    v_lshlrev_b32 v12, 16, v218
    v_and_b32 v16, 0xffff0000, v218
    v_mul_f32 v12, s86, v12
    v_mul_f32 v16, s86, v16
    v_lshlrev_b32 v13, 16, v219
    v_and_b32 v17, 0xffff0000, v219
    v_mul_f32 v13, s86, v13
    v_mul_f32 v17, s86, v17
    v_cvt_pk_bf16_f32 v18, v10, v11
    v_lshlrev_b32 v19, 16, v18
    v_and_b32 v20, 0xffff0000, v18
    v_sub_f32 v19, v10, v19
    v_sub_f32 v20, v11, v20
    v_cvt_pk_bf16_f32 v19, v19, v20
    v_cndmask_b32 v192, v19, v18, vcc

    v_cvt_pk_bf16_f32 v18, v12, v13
    v_lshlrev_b32 v19, 16, v18
    v_and_b32 v20, 0xffff0000, v18
    v_sub_f32 v19, v12, v19
    v_sub_f32 v20, v13, v20
    v_cvt_pk_bf16_f32 v19, v19, v20
    v_cndmask_b32 v193, v19, v18, vcc

    v_cvt_pk_bf16_f32 v18, v14, v15
    v_lshlrev_b32 v19, 16, v18
    v_and_b32 v20, 0xffff0000, v18
    v_sub_f32 v19, v14, v19
    v_sub_f32 v20, v15, v20
    v_cvt_pk_bf16_f32 v19, v19, v20
    v_cndmask_b32 v196, v19, v18, vcc

    v_cvt_pk_bf16_f32 v18, v16, v17
    v_lshlrev_b32 v19, 16, v18
    v_and_b32 v20, 0xffff0000, v18
    v_sub_f32 v19, v16, v19
    v_sub_f32 v20, v17, v20
    v_cvt_pk_bf16_f32 v19, v19, v20
    v_cndmask_b32 v197, v19, v18, vcc

    s_waitcnt lgkmcnt(0)
    v_perm_b32 v12, v209, v208, s38
    v_perm_b32 v16, v209, v208, s39
    v_perm_b32 v13, v211, v210, s38
    v_perm_b32 v17, v211, v210, s39
    v_perm_b32 v14, v213, v212, s38
    v_perm_b32 v18, v213, v212, s39
    v_perm_b32 v15, v215, v214, s38
    v_perm_b32 v19, v215, v214, s39
    ds_write_b128 v122, v[12:15] offset:2048
    ds_write_b128 v122, v[16:19] offset:3072
    v_lshlrev_b32 v208, 16, v200
    v_and_b32 v200, 0xffff0000, v200
    v_mul_f32 v208, s70, v208
    v_mul_f32 v200, s70, v200
    v_lshlrev_b32 v209, 16, v201
    v_and_b32 v201, 0xffff0000, v201
    v_mul_f32 v209, s70, v209
    v_mul_f32 v201, s70, v201
    v_lshlrev_b32 v210, 16, v202
    v_and_b32 v202, 0xffff0000, v202
    v_mul_f32 v210, s70, v210
    v_mul_f32 v202, s70, v202
    v_lshlrev_b32 v211, 16, v203
    v_and_b32 v203, 0xffff0000, v203
    v_mul_f32 v211, s70, v211
    v_mul_f32 v203, s70, v203
    v_lshlrev_b32 v212, 16, v204
    v_and_b32 v204, 0xffff0000, v204
    v_mul_f32 v212, s70, v212
    v_mul_f32 v204, s70, v204
    v_lshlrev_b32 v213, 16, v205
    v_and_b32 v205, 0xffff0000, v205
    v_mul_f32 v213, s70, v213
    v_mul_f32 v205, s70, v205
    v_lshlrev_b32 v214, 16, v206
    v_and_b32 v206, 0xffff0000, v206
    v_mul_f32 v214, s70, v214
    v_mul_f32 v206, s70, v206
    v_lshlrev_b32 v215, 16, v207
    v_and_b32 v207, 0xffff0000, v207
    v_mul_f32 v215, s70, v215
    v_mul_f32 v207, s70, v207
    v_cvt_pk_bf16_f32 v20, v208, v209
    v_cvt_pk_bf16_f32 v24, v200, v201
    v_cvt_pk_bf16_f32 v21, v210, v211
    v_cvt_pk_bf16_f32 v25, v202, v203
    v_cvt_pk_bf16_f32 v22, v212, v213
    v_cvt_pk_bf16_f32 v26, v204, v205
    v_cvt_pk_bf16_f32 v23, v214, v215
    v_cvt_pk_bf16_f32 v27, v206, v207
    ds_write_b128 v122, v[20:23]
    ds_write_b128 v122, v[24:27] offset:1024
    s_and_b32 s42, s21, 1
    s_lshl_b32 s42, s42, 12
    s_cmp_ge_u32 s21, 2
    s_cselect_b32 s43, 33536, 0
    s_add_u32 s42, s42, s43
    s_add_u32 s46, s42, 25088

    v_xor_b32 v248, 0, v61
    v_add_u32 v124, s46, v248
    v_add_u32 v248, s29, v248
    v_xor_b32 v249, 32, v61
    v_add_u32 v125, s46, v249
    v_add_u32 v249, s29, v249
    v_xor_b32 v250, 64, v61
    v_add_u32 v126, s46, v250
    v_add_u32 v250, s29, v250
    v_xor_b32 v251, 96, v61
    v_add_u32 v127, s46, v251
    v_add_u32 v251, s29, v251
    v_xor_b32 v4, 0, v60
    v_lshlrev_b32 v11, 4, v4
    v_xor_b32 v4, 2, v60
    v_lshlrev_b32 v13, 4, v4
    v_xor_b32 v4, 4, v60
    v_lshlrev_b32 v15, 4, v4
    v_xor_b32 v4, 6, v60
    v_lshlrev_b32 v17, 4, v4
    v_lshrrev_b32 v3, 3, v36
    s_lshl_b32 s38, s21, 13
    s_add_u32 s38, s38, s37
    v_lshl_add_u32 v10, v3, 8, s38
    v_add_u32 v12, 2048, v10
    v_add_u32 v14, 4096, v10
    v_add_u32 v16, 6144, v10
    v_mov_b32 v1, 151104
    v_mov_b32 v18, 0
    s_mul_i32 s38, s2, 2048
    s_add_u32 s38, s38, 65536
    s_mov_b32 m0, s46
    s_cmp_eq_u32 s20, 7
    s_cselect_b32 s40, s23, 0
    s_mov_b32 s23, 0
    s_cmp_eq_u32 s40, 0
    s_waitcnt vmcnt(0) lgkmcnt(0)
    s_barrier
    s_cbranch_scc1 K2_NOPUB

    buffer_store_dwordx4 v[112:115], v8, s[16:19], s38 offen offset:0 sc1
    buffer_store_dwordx4 v[116:119], v8, s[16:19], s38 offen offset:16 sc1
K2_NOPUB:
    ds_read_b64 v[30:31], v1 offset:8
    ds_write_b32 v1, v18 offset:4

    buffer_load_dwordx4 v[10:11], s[8:11], 0 idxen offen lds
    s_add_u32 m0, m0, 1024
    s_nop 0
    buffer_load_dwordx4 v[12:13], s[8:11], 0 idxen offen lds
    s_add_u32 m0, m0, 1024
    s_nop 0
    buffer_load_dwordx4 v[14:15], s[8:11], 0 idxen offen lds
    s_add_u32 m0, m0, 1024
    s_nop 0
    buffer_load_dwordx4 v[16:17], s[8:11], 0 idxen offen lds
    ds_read_b128 v[128:131], v33 offset:2048
    ds_read_b128 v[132:135], v33 offset:6144
    ds_read_b128 v[136:139], v33 offset:10240
    ds_read_b128 v[140:143], v33 offset:14336
    ds_read_b128 v[144:147], v33 offset:3072
    ds_read_b128 v[148:151], v33 offset:7168
    ds_read_b128 v[152:155], v33 offset:11264
    ds_read_b128 v[156:159], v33 offset:15360
    ds_read_b128 v[160:163], v32 offset:16384
    ds_read_b128 v[164:167], v32 offset:20480
    ds_read_b128 v[168:171], v32 offset:24576
    ds_read_b128 v[172:175], v32 offset:28672
    ds_read_b128 v[176:179], v32 offset:17408
    ds_read_b128 v[180:183], v32 offset:21504
    ds_read_b128 v[184:187], v32 offset:25600
    ds_read_b128 v[188:191], v32 offset:29696
    s_waitcnt lgkmcnt(15)
    v_readfirstlane_b32 s80, v30
    v_lshlrev_b32 v31, 24, v31
    s_nop 0
    v_readfirstlane_b32 s81, v31

K2_ROUND:
    s_lshl_b32 s44, s37, 3
    s_mul_i32 s39, s20, 2048
    s_add_u32 s44, s44, s39
    s_add_u32 s44, s44, 65536
    v_lshlrev_b32 v3, 4, v0
    v_mov_b32 v4, 2181103615
    v_mov_b32 v5, v4
    v_mov_b32 v6, v4
    v_mov_b32 v7, v4
    v_add_u32 v1, 99840, v3
    v_mov_b32 v16, 0
    v_mov_b32 v17, 0
    v_mov_b32 v18, 0
    v_mov_b32 v19, 0
    ds_write_b128 v1, v[4:7]
    ds_write_b128 v1, v[4:7] offset:8192
    ds_write_b128 v1, v[16:19] offset:16384
    ds_write_b128 v1, v[16:19] offset:24576
    ds_write_b128 v1, v[16:19] offset:32768
    ds_write_b128 v1, v[16:19] offset:40960
    v_lshlrev_b32 v3, 3, v0
    v_add_u32 v1, 148992, v3
    v_mov_b32 v4, 0x7fff
    s_movk_i32 s40, 264
    v_cmp_lt_u32 vcc, 127, v0
    v_cmp_gt_u32 s[38:39], s40, v0
    v_lshlrev_b32 v2, 2, v36
    v_cndmask_b32 v20, v16, v4, vcc
    v_mov_b32 v21, 0
    ds_write_b32 v2, v16 offset:33280
    v_add_u32 v2, 66816, v2
    ds_write_b32 v2, v16
    s_mov_b64 exec, s[38:39]
    ds_write_b64 v1, v[20:21]
    s_mov_b64 exec, -1
    v_mov_b32 v1, 151104
    ds_write_b32 v1, v16
    v_mov_b32 v38, v62
    v_lshrrev_b32 v39, 3, v36
    v_lshlrev_b32 v39, 2, v39
    v_lshrrev_b32 v40, 5, v36
    v_lshlrev_b32 v40, 11, v40
    v_and_b32 v1, 15, v36
    v_cmp_gt_u32 vcc, s26, v1
    v_add_u32 v1, s25, v1
    v_mul_u32_u24 v2, 12, v1
    v_add_u32 v2, 1048576, v2
    v_mov_b32 v3, 0x7fffffff
    v_cndmask_b32 v1, v3, v1, vcc
    s_cmp_eq_u32 s26, 32
    s_cselect_b32 s38, 16, 0x40000000
    v_add_u32 v3, s38, v1
    v_and_b32 v4, 31, v36
    s_lshl_b32 s38, s20, 0
    v_lshl_add_u32 v4, v4, 3, s38
    s_movk_i32 s39, 250
    v_cmp_le_u32 s[40:41], s39, v4
    s_movk_i32 s39, 3200
    v_mul_lo_u32 v4, v4, s39
    v_lshrrev_b32 v5, 4, v36
    v_lshlrev_b32 v5, 5, v5
    s_mov_b32 s45, 0
    v_mul_u32_u24 v21, 16384, v36
    s_mov_b32 s41, -1

    s_waitcnt lgkmcnt(0)
    s_barrier

    s_cmp_eq_u32 s84, 0
    s_cbranch_scc1 K2_REPOLL
    s_waitcnt vmcnt(0)
    s_mov_b32 exec_hi, 0
    buffer_load_dwordx2 v[22:23], v21, s[16:19], s44 offen sc1
    s_mov_b32 exec_hi, -1

    ds_read_b128 v[200:203], v124
    ds_read_b128 v[204:207], v125
    ds_read_b128 v[208:211], v126
    ds_read_b128 v[212:215], v127
    s_waitcnt lgkmcnt(3)
    v_mfma_f32_32x32x16_bf16 v[216:231], v[200:203], v[128:131], 0
    v_mfma_f32_32x32x16_bf16 v[232:247], v[200:203], v[144:147], 0
    s_waitcnt lgkmcnt(2)
    v_mfma_f32_32x32x16_bf16 v[216:231], v[204:207], v[132:135], v[216:231]
    v_mfma_f32_32x32x16_bf16 v[232:247], v[204:207], v[148:151], v[232:247]
    s_waitcnt lgkmcnt(1)
    v_mfma_f32_32x32x16_bf16 v[216:231], v[208:211], v[136:139], v[216:231]
    v_mfma_f32_32x32x16_bf16 v[232:247], v[208:211], v[152:155], v[232:247]
    s_waitcnt lgkmcnt(0)
    v_mfma_f32_32x32x16_bf16 v[216:231], v[212:215], v[140:143], v[216:231]
    v_mfma_f32_32x32x16_bf16 v[232:247], v[212:215], v[156:159], v[232:247]
    s_branch K2_POLL
K2_REPOLL:
    s_add_u32 s45, s45, 1
    s_cmp_gt_u32 s45, 200000
    s_cbranch_scc1 K2_POLLD

    s_mov_b32 exec_hi, 0
    buffer_load_dwordx2 v[22:23], v21, s[16:19], s44 offen sc1
    s_mov_b64 exec, -1
K2_POLL:
    s_waitcnt vmcnt(0)
    v_and_b32 v6, 0xff000000, v22
    v_cmp_eq_u32 vcc, s80, v23
    v_cmp_eq_u32 s[38:39], s81, v6
    s_and_b64 vcc, vcc, s[38:39]
    s_or_b64 s[38:39], vcc, s[40:41]
    s_cmp_eq_u64 s[38:39], -1
    s_cbranch_scc0 K2_REPOLL
K2_POLLD:
    s_andn2_b64 vcc, vcc, s[40:41]
    v_and_b32 v6, 0xfff, v22
    v_bfe_u32 v7, v22, 12, 12
    v_add_u32 v6, v6, v4
    v_lshl_or_b32 v6, v6, 12, v7
    v_cndmask_b32 v6, 0, v6, vcc

    ds_bpermute_b32 v8, v5, v6 offset:0
    ds_bpermute_b32 v9, v5, v6 offset:4
    ds_bpermute_b32 v10, v5, v6 offset:8
    ds_bpermute_b32 v11, v5, v6 offset:12
    ds_bpermute_b32 v12, v5, v6 offset:16
    ds_bpermute_b32 v13, v5, v6 offset:20
    ds_bpermute_b32 v14, v5, v6 offset:24
    ds_bpermute_b32 v15, v5, v6 offset:28
    s_waitcnt lgkmcnt(7)
    v_and_b32 v16, 0xfff, v8
    v_lshrrev_b32 v24, 12, v8
    v_cmp_lt_u32 s[64:65], v3, v16
    v_mad_u32_u24 v24, v24, 12, v2
    v_cmp_lt_u32 s[48:49], v1, v16

    s_waitcnt lgkmcnt(6)
    v_and_b32 v17, 0xfff, v9
    v_lshrrev_b32 v25, 12, v9
    v_cmp_lt_u32 s[66:67], v3, v17
    v_mad_u32_u24 v25, v25, 12, v2
    v_cmp_lt_u32 s[50:51], v1, v17

    s_waitcnt lgkmcnt(5)
    v_and_b32 v18, 0xfff, v10
    v_lshrrev_b32 v26, 12, v10
    v_cmp_lt_u32 s[68:69], v3, v18
    v_mad_u32_u24 v26, v26, 12, v2
    v_cmp_lt_u32 s[52:53], v1, v18

    s_waitcnt lgkmcnt(4)
    v_and_b32 v19, 0xfff, v11
    v_lshrrev_b32 v27, 12, v11
    v_cmp_lt_u32 s[70:71], v3, v19
    v_mad_u32_u24 v27, v27, 12, v2
    v_cmp_lt_u32 s[54:55], v1, v19

    s_waitcnt lgkmcnt(3)
    v_and_b32 v20, 0xfff, v12
    v_lshrrev_b32 v28, 12, v12
    v_cmp_lt_u32 s[72:73], v3, v20
    v_mad_u32_u24 v28, v28, 12, v2
    v_cmp_lt_u32 s[56:57], v1, v20

    s_waitcnt lgkmcnt(2)
    v_and_b32 v21, 0xfff, v13
    v_lshrrev_b32 v29, 12, v13
    v_cmp_lt_u32 s[74:75], v3, v21
    v_mad_u32_u24 v29, v29, 12, v2
    v_cmp_lt_u32 s[58:59], v1, v21

    s_waitcnt lgkmcnt(1)
    v_and_b32 v22, 0xfff, v14
    v_lshrrev_b32 v30, 12, v14
    v_cmp_lt_u32 s[76:77], v3, v22
    v_mad_u32_u24 v30, v30, 12, v2
    v_cmp_lt_u32 s[60:61], v1, v22

    s_waitcnt lgkmcnt(0)
    v_and_b32 v23, 0xfff, v15
    v_lshrrev_b32 v31, 12, v15
    v_cmp_lt_u32 s[78:79], v3, v23
    v_mad_u32_u24 v31, v31, 12, v2
    v_cmp_lt_u32 s[62:63], v1, v23

    s_mov_b64 exec, s[64:65]
    s_cbranch_execz K2_LB0
    buffer_load_dwordx3 v[96:98], v24, s[16:19], 0 offen offset:192 sc1
K2_LB0:

    s_mov_b64 exec, s[66:67]
    s_cbranch_execz K2_LB1
    buffer_load_dwordx3 v[100:102], v25, s[16:19], 0 offen offset:192 sc1
K2_LB1:

    s_mov_b64 exec, s[68:69]
    s_cbranch_execz K2_LB2
    buffer_load_dwordx3 v[104:106], v26, s[16:19], 0 offen offset:192 sc1
K2_LB2:

    s_mov_b64 exec, s[70:71]
    s_cbranch_execz K2_LB3
    buffer_load_dwordx3 v[108:110], v27, s[16:19], 0 offen offset:192 sc1
K2_LB3:

    s_mov_b64 exec, s[72:73]
    s_cbranch_execz K2_LB4
    buffer_load_dwordx3 v[112:114], v28, s[16:19], 0 offen offset:192 sc1
K2_LB4:

    s_mov_b64 exec, s[74:75]
    s_cbranch_execz K2_LB5
    buffer_load_dwordx3 v[116:118], v29, s[16:19], 0 offen offset:192 sc1
K2_LB5:

    s_mov_b64 exec, s[76:77]
    s_cbranch_execz K2_LB6
    buffer_load_dwordx3 v[120:122], v30, s[16:19], 0 offen offset:192 sc1
K2_LB6:

    s_mov_b64 exec, s[78:79]
    s_cbranch_execz K2_LB7
    buffer_load_dwordx3 v[124:126], v31, s[16:19], 0 offen offset:192 sc1
K2_LB7:

    s_mov_b64 exec, s[48:49]
    buffer_load_dwordx3 v[64:66], v24, s[16:19], 0 offen sc1

    s_mov_b64 exec, s[50:51]
    buffer_load_dwordx3 v[68:70], v25, s[16:19], 0 offen sc1

    s_mov_b64 exec, s[52:53]
    buffer_load_dwordx3 v[72:74], v26, s[16:19], 0 offen sc1

    s_mov_b64 exec, s[54:55]
    buffer_load_dwordx3 v[76:78], v27, s[16:19], 0 offen sc1

    s_mov_b64 exec, s[56:57]
    buffer_load_dwordx3 v[80:82], v28, s[16:19], 0 offen sc1

    s_mov_b64 exec, s[58:59]
    buffer_load_dwordx3 v[84:86], v29, s[16:19], 0 offen sc1

    s_mov_b64 exec, s[60:61]
    buffer_load_dwordx3 v[88:90], v30, s[16:19], 0 offen sc1

    s_mov_b64 exec, s[62:63]
    buffer_load_dwordx3 v[92:94], v31, s[16:19], 0 offen sc1

    s_mov_b64 exec, -1
    s_cmp_eq_u32 s84, 0
    s_cbranch_scc1 K2_NOINIT
    s_mov_b32 s84, 0

    ds_read_b128 v[128:131], v32 offset:0
    ds_read_b128 v[132:135], v32 offset:4096
    ds_read_b128 v[136:139], v32 offset:8192
    ds_read_b128 v[140:143], v32 offset:12288
    ds_read_b128 v[144:147], v32 offset:1024
    ds_read_b128 v[148:151], v32 offset:5120
    ds_read_b128 v[152:155], v32 offset:9216
    ds_read_b128 v[156:159], v32 offset:13312
    s_lshl_b32 s40, s21, 13
    s_mul_i32 s43, s22, 33536
    s_add_u32 s40, s40, s43
    v_lshlrev_b32 v2, 12, v34
    v_add3_u32 v2, v2, v41, s40
    s_cmp_eq_u32 s22, 0
    s_cbranch_scc0 K2_NOSPLIT

    v_pk_mul_f32 v[216:217], v[216:217], s[86:87]
    v_cvt_pk_bf16_f32 v4, v216, v217
    v_lshlrev_b32 v6, 16, v4
    v_and_b32 v7, 0xffff0000, v4
    v_pk_add_f32 v[216:217], v[216:217], v[6:7] neg_lo:[0,1] neg_hi:[0,1]
    v_cvt_pk_bf16_f32 v216, v6, v216
    v_cvt_pk_bf16_f32 v217, v7, v217

    v_pk_mul_f32 v[218:219], v[218:219], s[86:87]
    v_cvt_pk_bf16_f32 v4, v218, v219
    v_lshlrev_b32 v6, 16, v4
    v_and_b32 v7, 0xffff0000, v4
    v_pk_add_f32 v[218:219], v[218:219], v[6:7] neg_lo:[0,1] neg_hi:[0,1]
    v_cvt_pk_bf16_f32 v218, v6, v218
    v_cvt_pk_bf16_f32 v219, v7, v219

    v_pk_mul_f32 v[220:221], v[220:221], s[86:87]
    v_cvt_pk_bf16_f32 v4, v220, v221
    v_lshlrev_b32 v6, 16, v4
    v_and_b32 v7, 0xffff0000, v4
    v_pk_add_f32 v[220:221], v[220:221], v[6:7] neg_lo:[0,1] neg_hi:[0,1]
    v_cvt_pk_bf16_f32 v220, v6, v220
    v_cvt_pk_bf16_f32 v221, v7, v221

    v_pk_mul_f32 v[222:223], v[222:223], s[86:87]
    v_cvt_pk_bf16_f32 v4, v222, v223
    v_lshlrev_b32 v6, 16, v4
    v_and_b32 v7, 0xffff0000, v4
    v_pk_add_f32 v[222:223], v[222:223], v[6:7] neg_lo:[0,1] neg_hi:[0,1]
    v_cvt_pk_bf16_f32 v222, v6, v222
    v_cvt_pk_bf16_f32 v223, v7, v223

    v_pk_mul_f32 v[224:225], v[224:225], s[86:87]
    v_cvt_pk_bf16_f32 v4, v224, v225
    v_lshlrev_b32 v6, 16, v4
    v_and_b32 v7, 0xffff0000, v4
    v_pk_add_f32 v[224:225], v[224:225], v[6:7] neg_lo:[0,1] neg_hi:[0,1]
    v_cvt_pk_bf16_f32 v224, v6, v224
    v_cvt_pk_bf16_f32 v225, v7, v225

    v_pk_mul_f32 v[226:227], v[226:227], s[86:87]
    v_cvt_pk_bf16_f32 v4, v226, v227
    v_lshlrev_b32 v6, 16, v4
    v_and_b32 v7, 0xffff0000, v4
    v_pk_add_f32 v[226:227], v[226:227], v[6:7] neg_lo:[0,1] neg_hi:[0,1]
    v_cvt_pk_bf16_f32 v226, v6, v226
    v_cvt_pk_bf16_f32 v227, v7, v227

    v_pk_mul_f32 v[228:229], v[228:229], s[86:87]
    v_cvt_pk_bf16_f32 v4, v228, v229
    v_lshlrev_b32 v6, 16, v4
    v_and_b32 v7, 0xffff0000, v4
    v_pk_add_f32 v[228:229], v[228:229], v[6:7] neg_lo:[0,1] neg_hi:[0,1]
    v_cvt_pk_bf16_f32 v228, v6, v228
    v_cvt_pk_bf16_f32 v229, v7, v229

    v_pk_mul_f32 v[230:231], v[230:231], s[86:87]
    v_cvt_pk_bf16_f32 v4, v230, v231
    v_lshlrev_b32 v6, 16, v4
    v_and_b32 v7, 0xffff0000, v4
    v_pk_add_f32 v[230:231], v[230:231], v[6:7] neg_lo:[0,1] neg_hi:[0,1]
    v_cvt_pk_bf16_f32 v230, v6, v230
    v_cvt_pk_bf16_f32 v231, v7, v231

    v_pk_mul_f32 v[232:233], v[232:233], s[86:87]
    v_cvt_pk_bf16_f32 v4, v232, v233
    v_lshlrev_b32 v6, 16, v4
    v_and_b32 v7, 0xffff0000, v4
    v_pk_add_f32 v[232:233], v[232:233], v[6:7] neg_lo:[0,1] neg_hi:[0,1]
    v_cvt_pk_bf16_f32 v232, v6, v232
    v_cvt_pk_bf16_f32 v233, v7, v233

    v_pk_mul_f32 v[234:235], v[234:235], s[86:87]
    v_cvt_pk_bf16_f32 v4, v234, v235
    v_lshlrev_b32 v6, 16, v4
    v_and_b32 v7, 0xffff0000, v4
    v_pk_add_f32 v[234:235], v[234:235], v[6:7] neg_lo:[0,1] neg_hi:[0,1]
    v_cvt_pk_bf16_f32 v234, v6, v234
    v_cvt_pk_bf16_f32 v235, v7, v235

    v_pk_mul_f32 v[236:237], v[236:237], s[86:87]
    v_cvt_pk_bf16_f32 v4, v236, v237
    v_lshlrev_b32 v6, 16, v4
    v_and_b32 v7, 0xffff0000, v4
    v_pk_add_f32 v[236:237], v[236:237], v[6:7] neg_lo:[0,1] neg_hi:[0,1]
    v_cvt_pk_bf16_f32 v236, v6, v236
    v_cvt_pk_bf16_f32 v237, v7, v237

    v_pk_mul_f32 v[238:239], v[238:239], s[86:87]
    v_cvt_pk_bf16_f32 v4, v238, v239
    v_lshlrev_b32 v6, 16, v4
    v_and_b32 v7, 0xffff0000, v4
    v_pk_add_f32 v[238:239], v[238:239], v[6:7] neg_lo:[0,1] neg_hi:[0,1]
    v_cvt_pk_bf16_f32 v238, v6, v238
    v_cvt_pk_bf16_f32 v239, v7, v239

    v_pk_mul_f32 v[240:241], v[240:241], s[86:87]
    v_cvt_pk_bf16_f32 v4, v240, v241
    v_lshlrev_b32 v6, 16, v4
    v_and_b32 v7, 0xffff0000, v4
    v_pk_add_f32 v[240:241], v[240:241], v[6:7] neg_lo:[0,1] neg_hi:[0,1]
    v_cvt_pk_bf16_f32 v240, v6, v240
    v_cvt_pk_bf16_f32 v241, v7, v241

    v_pk_mul_f32 v[242:243], v[242:243], s[86:87]
    v_cvt_pk_bf16_f32 v4, v242, v243
    v_lshlrev_b32 v6, 16, v4
    v_and_b32 v7, 0xffff0000, v4
    v_pk_add_f32 v[242:243], v[242:243], v[6:7] neg_lo:[0,1] neg_hi:[0,1]
    v_cvt_pk_bf16_f32 v242, v6, v242
    v_cvt_pk_bf16_f32 v243, v7, v243

    v_pk_mul_f32 v[244:245], v[244:245], s[86:87]
    v_cvt_pk_bf16_f32 v4, v244, v245
    v_lshlrev_b32 v6, 16, v4
    v_and_b32 v7, 0xffff0000, v4
    v_pk_add_f32 v[244:245], v[244:245], v[6:7] neg_lo:[0,1] neg_hi:[0,1]
    v_cvt_pk_bf16_f32 v244, v6, v244
    v_cvt_pk_bf16_f32 v245, v7, v245

    v_pk_mul_f32 v[246:247], v[246:247], s[86:87]
    v_cvt_pk_bf16_f32 v4, v246, v247
    v_lshlrev_b32 v6, 16, v4
    v_and_b32 v7, 0xffff0000, v4
    v_pk_add_f32 v[246:247], v[246:247], v[6:7] neg_lo:[0,1] neg_hi:[0,1]
    v_cvt_pk_bf16_f32 v246, v6, v246
    v_cvt_pk_bf16_f32 v247, v7, v247

K2_NOSPLIT:
    s_cmp_eq_u32 s21, 3
    s_cselect_b32 exec_hi, 0, -1

    ds_write2_b32 v2, v216, v232 offset0:0 offset1:1
    ds_write2_b32 v2, v218, v234 offset0:64 offset1:65
    s_mov_b32 exec_hi, -1
    s_cbranch_scc1 K2_NOWR
    v_add_u32 v3, 1024, v2
    v_add_u32 v4, 2048, v2
    v_add_u32 v5, 3072, v2
    ds_write2_b32 v4, v217, v233 offset0:0 offset1:1
    ds_write2_b32 v4, v219, v235 offset0:64 offset1:65
    ds_write2_b32 v2, v220, v236 offset0:128 offset1:129
    ds_write2_b32 v4, v221, v237 offset0:128 offset1:129
    ds_write2_b32 v2, v222, v238 offset0:192 offset1:193
    ds_write2_b32 v4, v223, v239 offset0:192 offset1:193
    ds_write2_b32 v3, v224, v240 offset0:0 offset1:1
    ds_write2_b32 v5, v225, v241 offset0:0 offset1:1
    ds_write2_b32 v3, v226, v242 offset0:64 offset1:65
    ds_write2_b32 v5, v227, v243 offset0:64 offset1:65
    ds_write2_b32 v3, v228, v244 offset0:128 offset1:129
    ds_write2_b32 v5, v229, v245 offset0:128 offset1:129
    ds_write2_b32 v3, v230, v246 offset0:192 offset1:193
    ds_write2_b32 v5, v231, v247 offset0:192 offset1:193
K2_NOWR:
    v_xor_b32 v4, 0, v60
    v_lshlrev_b32 v241, 4, v4
    v_xor_b32 v4, 2, v60
    v_lshlrev_b32 v243, 4, v4
    v_xor_b32 v4, 4, v60
    v_lshlrev_b32 v245, 4, v4
    v_xor_b32 v4, 6, v60
    v_lshlrev_b32 v247, 4, v4
    v_lshlrev_b32 v4, 1, v34
    v_mov_b32 v5, 0x3f803f80
    v_cmp_eq_u32 vcc, v35, v4
    v_add_u32 v4, 1, v4
    v_cmp_eq_u32 s[38:39], v35, v4
    s_nop 0
    v_cndmask_b32 v234, 0, v5, vcc
    v_cndmask_b32 v238, 0, v5, vcc
    v_cndmask_b32 v235, 0, v5, s[38:39]
    v_cndmask_b32 v239, 0, v5, s[38:39]
K2_NOINIT:
    v_max3_u32 v4, v16, v17, v18
    v_max3_u32 v4, v19, v20, v4
    v_max3_u32 v4, v21, v22, v4
    v_max_u32 v4, v23, v4
    s_add_u32 s38, s25, s26
    v_cmp_lt_u32 vcc, s38, v4
    v_mov_b32 v5, 151104
    v_mov_b32 v6, 1
    v_mov_b32 v1, 4096
    s_mov_b64 exec, vcc
    ds_write_b32 v5, v6

    s_waitcnt vmcnt(8)
    s_mov_b64 exec, s[64:65]
    s_cbranch_execz K2_RK8
    v_lshrrev_b32 v24, 22, v98
    v_add_u32 v24, 148992, v24
    ds_add_rtn_u32 v99, v24, v1

K2_RK8:
    s_mov_b64 exec, s[66:67]
    s_cbranch_execz K2_RK9
    v_lshrrev_b32 v25, 22, v102
    v_add_u32 v25, 148992, v25
    ds_add_rtn_u32 v103, v25, v1

K2_RK9:
    s_mov_b64 exec, s[68:69]
    s_cbranch_execz K2_RK10
    v_lshrrev_b32 v26, 22, v106
    v_add_u32 v26, 148992, v26
    ds_add_rtn_u32 v107, v26, v1

K2_RK10:
    s_mov_b64 exec, s[70:71]
    s_cbranch_execz K2_RK11
    v_lshrrev_b32 v27, 22, v110
    v_add_u32 v27, 148992, v27
    ds_add_rtn_u32 v111, v27, v1

K2_RK11:
    s_mov_b64 exec, s[72:73]
    s_cbranch_execz K2_RK12
    v_lshrrev_b32 v28, 22, v114
    v_add_u32 v28, 148992, v28
    ds_add_rtn_u32 v115, v28, v1

K2_RK12:
    s_mov_b64 exec, s[74:75]
    s_cbranch_execz K2_RK13
    v_lshrrev_b32 v29, 22, v118
    v_add_u32 v29, 148992, v29
    ds_add_rtn_u32 v119, v29, v1

K2_RK13:
    s_mov_b64 exec, s[76:77]
    s_cbranch_execz K2_RK14
    v_lshrrev_b32 v30, 22, v122
    v_add_u32 v30, 148992, v30
    ds_add_rtn_u32 v123, v30, v1

K2_RK14:
    s_mov_b64 exec, s[78:79]
    s_cbranch_execz K2_RK15
    v_lshrrev_b32 v31, 22, v126
    v_add_u32 v31, 148992, v31
    ds_add_rtn_u32 v127, v31, v1

K2_RK15:
    s_waitcnt vmcnt(7)
    s_mov_b64 exec, s[48:49]
    v_lshrrev_b32 v16, 22, v66
    v_add_u32 v16, 148992, v16
    ds_add_rtn_u32 v67, v16, v1

    s_waitcnt vmcnt(6)
    s_mov_b64 exec, s[50:51]
    v_lshrrev_b32 v17, 22, v70
    v_add_u32 v17, 148992, v17
    ds_add_rtn_u32 v71, v17, v1

    s_waitcnt vmcnt(5)
    s_mov_b64 exec, s[52:53]
    v_lshrrev_b32 v18, 22, v74
    v_add_u32 v18, 148992, v18
    ds_add_rtn_u32 v75, v18, v1

    s_waitcnt vmcnt(4)
    s_mov_b64 exec, s[54:55]
    v_lshrrev_b32 v19, 22, v78
    v_add_u32 v19, 148992, v19
    ds_add_rtn_u32 v79, v19, v1

    s_waitcnt vmcnt(3)
    s_mov_b64 exec, s[56:57]
    v_lshrrev_b32 v20, 22, v82
    v_add_u32 v20, 148992, v20
    ds_add_rtn_u32 v83, v20, v1

    s_waitcnt vmcnt(2)
    s_mov_b64 exec, s[58:59]
    v_lshrrev_b32 v21, 22, v86
    v_add_u32 v21, 148992, v21
    ds_add_rtn_u32 v87, v21, v1

    s_waitcnt vmcnt(1)
    s_mov_b64 exec, s[60:61]
    v_lshrrev_b32 v22, 22, v90
    v_add_u32 v22, 148992, v22
    ds_add_rtn_u32 v91, v22, v1

    s_waitcnt vmcnt(0)
    s_mov_b64 exec, s[62:63]
    v_lshrrev_b32 v23, 22, v94
    v_add_u32 v23, 148992, v23
    ds_add_rtn_u32 v95, v23, v1

    s_mov_b64 exec, -1
    v_lshlrev_b32 v1, 3, v36
    v_add_u32 v1, 148992, v1
    v_lshrrev_b32 v8, 4, v36
    v_and_b32 v9, 15, v36
    s_lshl_b32 s42, s21, 3
    s_add_u32 s42, s42, s22
    v_lshl_add_u32 v10, v8, 1, s42
    v_lshlrev_b32 v11, 8, v10
    v_add_u32 v11, 25088, v11
    v_lshl_add_u32 v12, v9, 4, v11
    v_mov_b32 v32, 0
    v_mov_b32 v33, 0
    v_mov_b32 v34, 0
    v_mov_b32 v35, 0
    s_waitcnt lgkmcnt(0)
    s_barrier

    ds_read_b64 v[2:3], v1
    ds_write_b128 v12, v[32:35] offset:33536
    s_waitcnt lgkmcnt(1)
    v_add_u32 v2, 28672, v2
    v_add_u32 v3, 28672, v3
    v_lshrrev_b32 v2, 15, v2
    v_lshrrev_b32 v3, 15, v3
    v_add_u32 v4, v2, v3
    v_mov_b32 v5, v4

    s_nop 1
    v_add_u32_dpp v5, v5, v5 row_shr:1 row_mask:0xf bank_mask:0xf
    s_nop 1
    v_add_u32_dpp v5, v5, v5 row_shr:2 row_mask:0xf bank_mask:0xf
    s_nop 1
    v_add_u32_dpp v5, v5, v5 row_shr:4 row_mask:0xf bank_mask:0xf
    s_nop 1
    v_add_u32_dpp v5, v5, v5 row_shr:8 row_mask:0xf bank_mask:0xf
    s_nop 1
    v_add_u32_dpp v5, v5, v5 row_bcast:15 row_mask:0xa bank_mask:0xf
    s_nop 1
    v_add_u32_dpp v5, v5, v5 row_bcast:31 row_mask:0xc bank_mask:0xf
    v_sub_u32 v6, v5, v4
    v_readlane_b32 s38, v5, 63
    v_add_u32 v7, v6, v2
    v_lshlrev_b32 v6, 15, v6
    v_lshlrev_b32 v7, 15, v7
    ds_write_b64 v1, v[6:7] offset:512
    s_cmp_gt_u32 s38, 512
    s_cbranch_scc1 K2_CAP

    s_mov_b64 exec, s[48:49]
    ds_read_b32 v16, v16 offset:512
    s_mov_b64 exec, s[50:51]
    ds_read_b32 v17, v17 offset:512
    s_mov_b64 exec, s[52:53]
    ds_read_b32 v18, v18 offset:512
    s_mov_b64 exec, s[54:55]
    ds_read_b32 v19, v19 offset:512
    s_mov_b64 exec, s[56:57]
    ds_read_b32 v20, v20 offset:512
    s_mov_b64 exec, s[58:59]
    ds_read_b32 v21, v21 offset:512
    s_mov_b64 exec, s[60:61]
    ds_read_b32 v22, v22 offset:512
    s_mov_b64 exec, s[62:63]
    ds_read_b32 v23, v23 offset:512
    s_mov_b64 exec, s[64:65]
    s_cbranch_execz K2_NR8
    ds_read_b32 v24, v24 offset:512
K2_NR8:
    s_mov_b64 exec, s[66:67]
    s_cbranch_execz K2_NR9
    ds_read_b32 v25, v25 offset:512
K2_NR9:
    s_mov_b64 exec, s[68:69]
    s_cbranch_execz K2_NR10
    ds_read_b32 v26, v26 offset:512
K2_NR10:
    s_mov_b64 exec, s[70:71]
    s_cbranch_execz K2_NR11
    ds_read_b32 v27, v27 offset:512
K2_NR11:
    s_mov_b64 exec, s[72:73]
    s_cbranch_execz K2_NR12
    ds_read_b32 v28, v28 offset:512
K2_NR12:
    s_mov_b64 exec, s[74:75]
    s_cbranch_execz K2_NR13
    ds_read_b32 v29, v29 offset:512
K2_NR13:
    s_mov_b64 exec, s[76:77]
    s_cbranch_execz K2_NR14
    ds_read_b32 v30, v30 offset:512
K2_NR14:
    s_mov_b64 exec, s[78:79]
    s_cbranch_execz K2_NR15
    ds_read_b32 v31, v31 offset:512
K2_NR15:
    s_mov_b64 exec, -1
    s_add_u32 s38, s38, 15
    s_lshr_b32 s38, s38, 4
    s_max_u32 s38, s38, 1
    v_cvt_f32_u32 v2, s38
    v_rcp_f32 v2, v2
    s_add_u32 s39, s38, 1
    s_lshr_b32 s39, s39, 1
    s_sub_u32 s40, s38, s39
    v_mul_f32 v2, 0x48000000, v2
    v_cvt_u32_f32 v2, v2
    v_add_u32 v2, 1, v2
    s_cmp_eq_u32 s22, 0
    s_cselect_b32 s27, s39, s40
    s_cselect_b32 s34, 0, s39
    v_readfirstlane_b32 s35, v2
    s_lshl_b32 s41, s38, 6
    s_sub_u32 s36, 2048, s41
    s_lshl_b32 s38, s21, 10
    s_lshl_b32 s39, s34, 3
    s_add_u32 s38, s38, s39
    s_lshl_b32 s39, s38, 3
    s_add_u32 s39, s39, 116224
    s_lshl_b32 s40, s38, 2
    s_add_u32 s40, s40, 99840
    s_add_u32 s41, s40, 2
    v_add_u32 v38, s39, v38
    v_add_u32 v39, s40, v39
    v_add_u32 v40, s41, v40
    v_lshlrev_b32 v13, 10, v8
    v_add_u32 v13, s41, v13
    v_lshl_add_u32 v14, v9, 5, v13
    s_mov_b32 s42, 116224
    s_waitcnt lgkmcnt(0)

    s_mov_b64 exec, s[48:49]
    v_add_u32 v67, v16, v67
    v_mul_hi_u32_u24 v16, s35, v67
    v_lshrrev_b32 v67, 9, v67
    v_mad_u32_u24 v67, v16, s36, v67
    v_add_u32 v67, 116224, v67
    v_lshrrev_b32 v16, 1, v67
    ds_write_b32 v16, v66 offset:41728

    ds_write_b64 v67, v[64:65]
    s_mov_b64 exec, s[50:51]
    v_add_u32 v71, v17, v71
    v_mul_hi_u32_u24 v17, s35, v71
    v_lshrrev_b32 v71, 9, v71
    v_mad_u32_u24 v71, v17, s36, v71
    v_add_u32 v71, 116224, v71
    v_lshrrev_b32 v17, 1, v71
    ds_write_b32 v17, v70 offset:41728

    ds_write_b64 v71, v[68:69]
    s_mov_b64 exec, s[52:53]
    v_add_u32 v75, v18, v75
    v_mul_hi_u32_u24 v18, s35, v75
    v_lshrrev_b32 v75, 9, v75
    v_mad_u32_u24 v75, v18, s36, v75
    v_add_u32 v75, 116224, v75
    v_lshrrev_b32 v18, 1, v75
    ds_write_b32 v18, v74 offset:41728

    ds_write_b64 v75, v[72:73]
    s_mov_b64 exec, s[54:55]
    v_add_u32 v79, v19, v79
    v_mul_hi_u32_u24 v19, s35, v79
    v_lshrrev_b32 v79, 9, v79
    v_mad_u32_u24 v79, v19, s36, v79
    v_add_u32 v79, 116224, v79
    v_lshrrev_b32 v19, 1, v79
    ds_write_b32 v19, v78 offset:41728

    ds_write_b64 v79, v[76:77]
    s_mov_b64 exec, s[56:57]
    v_add_u32 v83, v20, v83
    v_mul_hi_u32_u24 v20, s35, v83
    v_lshrrev_b32 v83, 9, v83
    v_mad_u32_u24 v83, v20, s36, v83
    v_add_u32 v83, 116224, v83
    v_lshrrev_b32 v20, 1, v83
    ds_write_b32 v20, v82 offset:41728

    ds_write_b64 v83, v[80:81]
    s_mov_b64 exec, s[58:59]
    v_add_u32 v87, v21, v87
    v_mul_hi_u32_u24 v21, s35, v87
    v_lshrrev_b32 v87, 9, v87
    v_mad_u32_u24 v87, v21, s36, v87
    v_add_u32 v87, 116224, v87
    v_lshrrev_b32 v21, 1, v87
    ds_write_b32 v21, v86 offset:41728

    ds_write_b64 v87, v[84:85]
    s_mov_b64 exec, s[60:61]
    v_add_u32 v91, v22, v91
    v_mul_hi_u32_u24 v22, s35, v91
    v_lshrrev_b32 v91, 9, v91
    v_mad_u32_u24 v91, v22, s36, v91
    v_add_u32 v91, 116224, v91
    v_lshrrev_b32 v22, 1, v91
    ds_write_b32 v22, v90 offset:41728

    ds_write_b64 v91, v[88:89]
    s_mov_b64 exec, s[62:63]
    v_add_u32 v95, v23, v95
    v_mul_hi_u32_u24 v23, s35, v95
    v_lshrrev_b32 v95, 9, v95
    v_mad_u32_u24 v95, v23, s36, v95
    v_add_u32 v95, 116224, v95
    v_lshrrev_b32 v23, 1, v95
    ds_write_b32 v23, v94 offset:41728

    ds_write_b64 v95, v[92:93]
    s_mov_b64 exec, s[64:65]
    s_cbranch_execz K2_SC8
    v_add_u32 v99, v24, v99
    v_mul_hi_u32_u24 v24, s35, v99
    v_lshrrev_b32 v99, 9, v99
    v_mad_u32_u24 v99, v24, s36, v99
    v_add_u32 v99, 116224, v99
    v_lshrrev_b32 v24, 1, v99
    ds_write_b32 v24, v98 offset:41728

    ds_write_b64 v99, v[96:97]
K2_SC8:
    s_mov_b64 exec, s[66:67]
    s_cbranch_execz K2_SC9
    v_add_u32 v103, v25, v103
    v_mul_hi_u32_u24 v25, s35, v103
    v_lshrrev_b32 v103, 9, v103
    v_mad_u32_u24 v103, v25, s36, v103
    v_add_u32 v103, 116224, v103
    v_lshrrev_b32 v25, 1, v103
    ds_write_b32 v25, v102 offset:41728

    ds_write_b64 v103, v[100:101]
K2_SC9:
    s_mov_b64 exec, s[68:69]
    s_cbranch_execz K2_SC10
    v_add_u32 v107, v26, v107
    v_mul_hi_u32_u24 v26, s35, v107
    v_lshrrev_b32 v107, 9, v107
    v_mad_u32_u24 v107, v26, s36, v107
    v_add_u32 v107, 116224, v107
    v_lshrrev_b32 v26, 1, v107
    ds_write_b32 v26, v106 offset:41728

    ds_write_b64 v107, v[104:105]
K2_SC10:
    s_mov_b64 exec, s[70:71]
    s_cbranch_execz K2_SC11
    v_add_u32 v111, v27, v111
    v_mul_hi_u32_u24 v27, s35, v111
    v_lshrrev_b32 v111, 9, v111
    v_mad_u32_u24 v111, v27, s36, v111
    v_add_u32 v111, 116224, v111
    v_lshrrev_b32 v27, 1, v111
    ds_write_b32 v27, v110 offset:41728

    ds_write_b64 v111, v[108:109]
K2_SC11:
    s_mov_b64 exec, s[72:73]
    s_cbranch_execz K2_SC12
    v_add_u32 v115, v28, v115
    v_mul_hi_u32_u24 v28, s35, v115
    v_lshrrev_b32 v115, 9, v115
    v_mad_u32_u24 v115, v28, s36, v115
    v_add_u32 v115, 116224, v115
    v_lshrrev_b32 v28, 1, v115
    ds_write_b32 v28, v114 offset:41728

    ds_write_b64 v115, v[112:113]
K2_SC12:
    s_mov_b64 exec, s[74:75]
    s_cbranch_execz K2_SC13
    v_add_u32 v119, v29, v119
    v_mul_hi_u32_u24 v29, s35, v119
    v_lshrrev_b32 v119, 9, v119
    v_mad_u32_u24 v119, v29, s36, v119
    v_add_u32 v119, 116224, v119
    v_lshrrev_b32 v29, 1, v119
    ds_write_b32 v29, v118 offset:41728

    ds_write_b64 v119, v[116:117]
K2_SC13:
    s_mov_b64 exec, s[76:77]
    s_cbranch_execz K2_SC14
    v_add_u32 v123, v30, v123
    v_mul_hi_u32_u24 v30, s35, v123
    v_lshrrev_b32 v123, 9, v123
    v_mad_u32_u24 v123, v30, s36, v123
    v_add_u32 v123, 116224, v123
    v_lshrrev_b32 v30, 1, v123
    ds_write_b32 v30, v122 offset:41728

    ds_write_b64 v123, v[120:121]
K2_SC14:
    s_mov_b64 exec, s[78:79]
    s_cbranch_execz K2_SC15
    v_add_u32 v127, v31, v127
    v_mul_hi_u32_u24 v31, s35, v127
    v_lshrrev_b32 v127, 9, v127
    v_mad_u32_u24 v127, v31, s36, v127
    v_add_u32 v127, 116224, v127
    v_lshrrev_b32 v31, 1, v127
    ds_write_b32 v31, v126 offset:41728

    ds_write_b64 v127, v[124:125]
K2_SC15:
    s_mov_b64 exec, -1
    s_waitcnt lgkmcnt(0)
    s_barrier

    ds_read_u16 v240, v39 offset:0
    ds_read_u16 v242, v39 offset:1024
    ds_read_u16 v244, v39 offset:2048
    ds_read_u16 v246, v39 offset:3072
    ds_read_u16 v15, v13
    ds_read_u16 v16, v14
    s_mov_b32 s28, 0
    s_cmp_lt_u32 s27, 2
    s_cselect_b32 s6, 0, 25000
    s_waitcnt lgkmcnt(2)

    s_add_u32 m0, s29, 0
    s_nop 0
    buffer_load_dwordx4 v[240:241], s[8:11], 0 idxen offen lds
    s_add_u32 m0, s29, 1024
    s_nop 0
    buffer_load_dwordx4 v[242:243], s[8:11], 0 idxen offen lds
    s_add_u32 m0, s29, 2048
    s_nop 0
    buffer_load_dwordx4 v[244:245], s[8:11], 0 idxen offen lds
    s_add_u32 m0, s29, 3072
    s_nop 0
    buffer_load_dwordx4 v[246:247], s[8:11], 0 idxen offen lds
    ds_read_u16 v240, v39 offset:32
    ds_read_u16 v242, v39 offset:1056
    ds_read_u16 v244, v39 offset:2080
    ds_read_u16 v246, v39 offset:3104
    s_waitcnt lgkmcnt(4)
    v_lshl_add_u32 v17, v9, 4, v15
    ds_read_b128 v[32:35], v17 offset:0
    v_cmp_eq_u32 vcc, v15, v16
    v_cmp_gt_u32 s[38:39], s27, v9
    s_and_b64 exec, vcc, s[38:39]
    ds_write_b16 v14, v11
    v_cmp_eq_u32 vcc, 0, v9
    v_lshrrev_b32 v18, 5, v15
    v_add_u32 v18, 150016, v18
    v_add_u32 v19, 1, v10
    s_mov_b64 exec, vcc
    ds_min_u32 v18, v10
    ds_max_u32 v18, v19 offset:4
    s_mov_b64 exec, -1

    ds_read_u16 v252, v40 offset:0
    ds_read_u16 v253, v40 offset:1024
    s_waitcnt lgkmcnt(5)
    ds_write_b128 v12, v[32:35] offset:0
    s_waitcnt lgkmcnt(1)

    v_add_u32 v42, v252, v41
    v_add_u32 v43, v253, v41
    ds_read_b32 v194, v42 offset:0
    ds_read_b32 v195, v43 offset:0
    ds_read_b32 v198, v42 offset:4
    ds_read_b32 v199, v43 offset:4
    s_mov_b64 exec, -1
    v_add_u32 v44, 33280, v41
    v_add_u32 v45, 33280, v41
    v_mov_b32 v54, 0
    v_mov_b32 v55, 0
    v_mov_b32 v56, 1.0
    v_mov_b32 v57, 1.0
    v_mov_b32 v47, 0
    v_mov_b32 v49, 0
    v_mov_b32 v50, 0
    v_mov_b32 v52, 0

    v_lshrrev_b32 v2, 3, v0
    v_and_b32 v3, 7, v0
    v_mov_b32 v1, 151104
    v_mov_b32 v15, 1
    v_lshlrev_b32 v4, 5, v3
    v_lshl_add_u32 v5, v2, 8, v4
    v_add_u32 v5, 33536, v5
    v_lshlrev_b32 v6, 3, v2
    v_add_u32 v6, 150016, v6
    v_add_u32 v4, 58624, v4
    v_cmp_gt_u32 s[42:43], 34, v2
    v_lshlrev_b32 v12, 8, v2
    v_add_u32 v12, s37, v12
    v_lshlrev_b32 v13, 4, v3
    v_mov_b32 v32, 0
    v_mov_b32 v33, 0
    v_mov_b32 v34, 0
    v_mov_b32 v35, 0
    v_mov_b32 v7, 0x7b800000

    s_cmp_eq_u32 s27, 0
    s_cbranch_scc1 K2_DONE
    s_waitcnt vmcnt(0)
    ds_read_b128 v[200:203], v248
    ds_read_b128 v[204:207], v249
    ds_read_b128 v[208:211], v250
    ds_read_b128 v[212:215], v251
    ds_read_b64 v[232:233], v38 offset:0
    s_waitcnt lgkmcnt(4)
    v_mfma_f32_32x32x16_bf16 v[64:79], v[200:203], v[128:131], 0
    s_waitcnt lgkmcnt(3)
    v_mfma_f32_32x32x16_bf16 v[64:79], v[204:207], v[132:135], v[64:79]
    s_waitcnt lgkmcnt(2)
    v_mfma_f32_32x32x16_bf16 v[64:79], v[208:211], v[136:139], v[64:79]
    s_waitcnt lgkmcnt(1)
    v_mfma_f32_32x32x16_bf16 v[64:79], v[212:215], v[140:143], v[64:79]
    s_add_u32 m0, s29, 0
    s_nop 0
    buffer_load_dwordx4 v[240:241], s[4:7], 0 idxen offen lds
    s_add_u32 m0, s29, 1024
    s_nop 0
    buffer_load_dwordx4 v[242:243], s[4:7], 0 idxen offen lds
    s_add_u32 m0, s29, 2048
    s_nop 0
    buffer_load_dwordx4 v[244:245], s[4:7], 0 idxen offen lds
    s_add_u32 m0, s29, 3072
    s_nop 0
    buffer_load_dwordx4 v[246:247], s[4:7], 0 idxen offen lds
    ds_read_u16 v240, v39 offset:64
    ds_read_u16 v242, v39 offset:1088
    ds_read_u16 v244, v39 offset:2112
    ds_read_u16 v246, v39 offset:3136
    s_waitcnt lgkmcnt(0)
    v_mfma_f32_32x32x16_bf16 v[64:79], v[232:235], v[192:195], v[64:79]
    v_mfma_f32_32x32x16_bf16 v[80:95], v[200:203], v[160:163], 0
    v_mfma_f32_32x32x16_bf16 v[80:95], v[204:207], v[164:167], v[80:95]
    v_mfma_f32_32x32x16_bf16 v[80:95], v[208:211], v[168:171], v[80:95]
    v_mfma_f32_32x32x16_bf16 v[80:95], v[212:215], v[172:175], v[80:95]
    s_cmp_lg_u32 s24, 0
    s_cbranch_scc1 K2S_PRE
    s_nop 7
    .p2align 6
K2F_LOOP:

    ds_read_u16 v252, v40 offset:32
    ds_read_u16 v253, v40 offset:1056
    v_mfma_f32_32x32x16_bf16 v[96:111], v[200:203], v[144:147], 0
    v_rcp_f32 v58, v56
    v_rcp_f32 v59, v57
    v_max3_f32 v37, v56, v57, v37
    v_fma_f32 v51, v54, v58, v47
    v_mfma_f32_32x32x16_bf16 v[96:111], v[204:207], v[148:151], v[96:111]
    v_fma_f32 v53, v55, v59, v49
    v_exp_f32 v64, v64
    v_exp_f32 v65, v65
    s_waitcnt vmcnt(0)
    ds_read_b128 v[216:219], v248
    ds_read_b128 v[220:223], v249
    ds_read_b128 v[224:227], v250
    ds_read_b128 v[228:231], v251
    ds_read_b64 v[236:237], v38 offset:64
    ds_write_b64 v44, v[50:51] offset:33536
    ds_write_b64 v45, v[52:53] offset:33536
    v_mfma_f32_32x32x16_bf16 v[96:111], v[208:211], v[152:155], v[96:111]
    v_exp_f32 v66, v66
    v_exp_f32 v67, v67
    v_exp_f32 v68, v68
    v_mfma_f32_32x32x16_bf16 v[96:111], v[212:215], v[156:159], v[96:111]
    v_exp_f32 v69, v69
    v_exp_f32 v70, v70
    v_exp_f32 v71, v71
    s_waitcnt lgkmcnt(13)
    v_mfma_f32_32x32x16_bf16 v[96:111], v[232:235], v[196:199], v[96:111]
    s_waitcnt lgkmcnt(8)
    v_add_u32 v44, v252, v41
    s_waitcnt lgkmcnt(7)
    v_add_u32 v45, v253, v41
    v_exp_f32 v72, v72
    v_exp_f32 v73, v73
    v_mfma_f32_32x32x16_bf16 v[112:127], v[200:203], v[176:179], 0
    s_setprio 1
    v_exp_f32 v74, v74
    v_exp_f32 v75, v75
    v_add_f32 v56, 1.0, v64
    v_add_f32 v57, 1.0, v65
    v_mfma_f32_32x32x16_bf16 v[112:127], v[204:207], v[180:183], v[112:127]
    v_exp_f32 v76, v76
    v_exp_f32 v77, v77
    v_fma_f32 v54, v80, v66, v80
    v_fma_f32 v55, v81, v67, v81
    v_mfma_f32_32x32x16_bf16 v[112:127], v[208:211], v[184:187], v[112:127]
    v_exp_f32 v78, v78
    v_exp_f32 v79, v79
    v_fmac_f32 v54, v82, v56
    v_fmac_f32 v55, v83, v57
    v_mfma_f32_32x32x16_bf16 v[112:127], v[212:215], v[188:191], v[112:127]
    v_fmac_f32 v56, v56, v66
    v_fmac_f32 v57, v57, v67
    v_fmac_f32 v54, v54, v68
    v_fmac_f32 v55, v55, v69
    v_fmac_f32 v54, v84, v56
    v_fmac_f32 v55, v85, v57
    v_fmac_f32 v56, v56, v68
    v_fmac_f32 v57, v57, v69
    s_setprio 3
    ds_read_b64 v[46:47], v42 offset:33536
    ds_read_b64 v[48:49], v43 offset:33536
    ds_read_b32 v194, v44 offset:0
    ds_read_b32 v195, v45 offset:0
    ds_read_b32 v198, v44 offset:4
    ds_read_b32 v199, v45 offset:4
    s_add_u32 s28, s28, 1
    s_cmp_lt_u32 s28, s27
    v_pk_fma_f32 v[54:55], v[54:55], v[70:71], v[54:55]
    v_pk_fma_f32 v[54:55], v[86:87], v[56:57], v[54:55]
    v_pk_fma_f32 v[56:57], v[56:57], v[70:71], v[56:57]
    v_pk_fma_f32 v[54:55], v[54:55], v[72:73], v[54:55]
    v_pk_fma_f32 v[54:55], v[88:89], v[56:57], v[54:55]
    v_pk_fma_f32 v[56:57], v[56:57], v[72:73], v[56:57]
    v_pk_fma_f32 v[54:55], v[54:55], v[74:75], v[54:55]
    v_pk_fma_f32 v[54:55], v[90:91], v[56:57], v[54:55]
    v_pk_fma_f32 v[56:57], v[56:57], v[74:75], v[56:57]
    v_pk_fma_f32 v[54:55], v[54:55], v[76:77], v[54:55]
    v_pk_fma_f32 v[54:55], v[92:93], v[56:57], v[54:55]
    v_pk_fma_f32 v[56:57], v[56:57], v[76:77], v[56:57]
    v_pk_fma_f32 v[54:55], v[54:55], v[78:79], v[54:55]
    v_pk_fma_f32 v[54:55], v[94:95], v[56:57], v[54:55]
    v_pk_fma_f32 v[56:57], v[56:57], v[78:79], v[56:57]
    s_setprio 2
    s_cbranch_scc0 K2F_EXIT0
    s_add_u32 m0, s29, 0
    s_add_u32 s38, s28, 1
    s_cmp_lt_u32 s38, s27
    s_cselect_b32 s6, 25000, 0
    s_waitcnt lgkmcnt(9)
    buffer_load_dwordx4 v[240:241], s[4:7], 0 idxen offen lds
    s_add_u32 m0, s29, 1024
    s_nop 0
    buffer_load_dwordx4 v[242:243], s[4:7], 0 idxen offen lds
    s_add_u32 m0, s29, 2048
    s_nop 0
    buffer_load_dwordx4 v[244:245], s[4:7], 0 idxen offen lds
    s_add_u32 m0, s29, 3072
    s_nop 0
    buffer_load_dwordx4 v[246:247], s[4:7], 0 idxen offen lds
    v_mfma_f32_32x32x16_bf16 v[64:79], v[216:219], v[128:131], 0
    v_rcp_f32 v58, v56
    v_rcp_f32 v59, v57
    v_max3_f32 v37, v56, v57, v37
    s_waitcnt lgkmcnt(5)
    v_fma_f32 v50, v54, v58, v46
    v_mfma_f32_32x32x16_bf16 v[64:79], v[220:223], v[132:135], v[64:79]
    s_waitcnt lgkmcnt(4)
    v_fma_f32 v52, v55, v59, v48
    v_exp_f32 v96, v96
    v_exp_f32 v97, v97
    v_mfma_f32_32x32x16_bf16 v[64:79], v[224:227], v[136:139], v[64:79]
    v_exp_f32 v98, v98
    v_exp_f32 v99, v99
    v_exp_f32 v100, v100
    v_mfma_f32_32x32x16_bf16 v[64:79], v[228:231], v[140:143], v[64:79]
    v_exp_f32 v101, v101
    v_exp_f32 v102, v102
    v_exp_f32 v103, v103
    s_waitcnt lgkmcnt(2)
    v_mfma_f32_32x32x16_bf16 v[64:79], v[236:239], v[192:195], v[64:79]
    v_exp_f32 v104, v104
    v_exp_f32 v105, v105
    v_add_f32 v56, 1.0, v96
    v_add_f32 v57, 1.0, v97
    v_mfma_f32_32x32x16_bf16 v[80:95], v[216:219], v[160:163], 0
    s_setprio 1
    v_exp_f32 v106, v106
    v_exp_f32 v107, v107
    v_fma_f32 v54, v112, v98, v112
    v_fma_f32 v55, v113, v99, v113
    v_mfma_f32_32x32x16_bf16 v[80:95], v[220:223], v[164:167], v[80:95]
    v_exp_f32 v108, v108
    v_exp_f32 v109, v109
    v_fmac_f32 v54, v114, v56
    v_fmac_f32 v55, v115, v57
    v_mfma_f32_32x32x16_bf16 v[80:95], v[224:227], v[168:171], v[80:95]
    v_exp_f32 v110, v110
    v_exp_f32 v111, v111
    v_fmac_f32 v56, v56, v98
    v_fmac_f32 v57, v57, v99
    v_mfma_f32_32x32x16_bf16 v[80:95], v[228:231], v[172:175], v[80:95]
    v_fmac_f32 v54, v54, v100
    v_fmac_f32 v55, v55, v101
    v_fmac_f32 v54, v116, v56
    v_fmac_f32 v55, v117, v57
    v_fmac_f32 v56, v56, v100
    v_fmac_f32 v57, v57, v101
    s_setprio 3
    ds_read_u16 v240, v39 offset:96
    ds_read_u16 v242, v39 offset:1120
    ds_read_u16 v244, v39 offset:2144
    ds_read_u16 v246, v39 offset:3168
    v_pk_fma_f32 v[54:55], v[54:55], v[102:103], v[54:55]
    v_pk_fma_f32 v[54:55], v[118:119], v[56:57], v[54:55]
    v_pk_fma_f32 v[56:57], v[56:57], v[102:103], v[56:57]
    v_pk_fma_f32 v[54:55], v[54:55], v[104:105], v[54:55]
    v_pk_fma_f32 v[54:55], v[120:121], v[56:57], v[54:55]
    v_pk_fma_f32 v[56:57], v[56:57], v[104:105], v[56:57]
    v_pk_fma_f32 v[54:55], v[54:55], v[106:107], v[54:55]
    v_pk_fma_f32 v[54:55], v[122:123], v[56:57], v[54:55]
    v_pk_fma_f32 v[56:57], v[56:57], v[106:107], v[56:57]
    v_pk_fma_f32 v[54:55], v[54:55], v[108:109], v[54:55]
    v_pk_fma_f32 v[54:55], v[124:125], v[56:57], v[54:55]
    v_pk_fma_f32 v[56:57], v[56:57], v[108:109], v[56:57]
    v_pk_fma_f32 v[54:55], v[54:55], v[110:111], v[54:55]
    v_pk_fma_f32 v[54:55], v[126:127], v[56:57], v[54:55]
    v_pk_fma_f32 v[56:57], v[56:57], v[110:111], v[56:57]
    s_setprio 2
    ds_read_u16 v252, v40 offset:64
    ds_read_u16 v253, v40 offset:1088
    v_mfma_f32_32x32x16_bf16 v[96:111], v[216:219], v[144:147], 0
    v_rcp_f32 v58, v56
    v_rcp_f32 v59, v57
    v_max3_f32 v37, v56, v57, v37
    v_fma_f32 v51, v54, v58, v47
    v_mfma_f32_32x32x16_bf16 v[96:111], v[220:223], v[148:151], v[96:111]
    v_fma_f32 v53, v55, v59, v49
    v_exp_f32 v64, v64
    v_exp_f32 v65, v65
    s_waitcnt vmcnt(0)
    ds_read_b128 v[200:203], v248
    ds_read_b128 v[204:207], v249
    ds_read_b128 v[208:211], v250
    ds_read_b128 v[212:215], v251
    ds_read_b64 v[232:233], v38 offset:128
    ds_write_b64 v42, v[50:51] offset:33536
    ds_write_b64 v43, v[52:53] offset:33536
    v_mfma_f32_32x32x16_bf16 v[96:111], v[224:227], v[152:155], v[96:111]
    v_exp_f32 v66, v66
    v_exp_f32 v67, v67
    v_exp_f32 v68, v68
    v_mfma_f32_32x32x16_bf16 v[96:111], v[228:231], v[156:159], v[96:111]
    v_exp_f32 v69, v69
    v_exp_f32 v70, v70
    v_exp_f32 v71, v71
    s_waitcnt lgkmcnt(13)
    v_mfma_f32_32x32x16_bf16 v[96:111], v[236:239], v[196:199], v[96:111]
    s_waitcnt lgkmcnt(8)
    v_add_u32 v42, v252, v41
    s_waitcnt lgkmcnt(7)
    v_add_u32 v43, v253, v41
    v_exp_f32 v72, v72
    v_exp_f32 v73, v73
    v_mfma_f32_32x32x16_bf16 v[112:127], v[216:219], v[176:179], 0
    s_setprio 1
    v_exp_f32 v74, v74
    v_exp_f32 v75, v75
    v_add_f32 v56, 1.0, v64
    v_add_f32 v57, 1.0, v65
    v_mfma_f32_32x32x16_bf16 v[112:127], v[220:223], v[180:183], v[112:127]
    v_exp_f32 v76, v76
    v_exp_f32 v77, v77
    v_fma_f32 v54, v80, v66, v80
    v_fma_f32 v55, v81, v67, v81
    v_mfma_f32_32x32x16_bf16 v[112:127], v[224:227], v[184:187], v[112:127]
    v_exp_f32 v78, v78
    v_exp_f32 v79, v79
    v_fmac_f32 v54, v82, v56
    v_fmac_f32 v55, v83, v57
    v_mfma_f32_32x32x16_bf16 v[112:127], v[228:231], v[188:191], v[112:127]
    v_fmac_f32 v56, v56, v66
    v_fmac_f32 v57, v57, v67
    v_fmac_f32 v54, v54, v68
    v_fmac_f32 v55, v55, v69
    v_fmac_f32 v54, v84, v56
    v_fmac_f32 v55, v85, v57
    v_fmac_f32 v56, v56, v68
    v_fmac_f32 v57, v57, v69
    s_setprio 3
    ds_read_b64 v[46:47], v44 offset:33536
    ds_read_b64 v[48:49], v45 offset:33536
    ds_read_b32 v194, v42 offset:0
    ds_read_b32 v195, v43 offset:0
    ds_read_b32 v198, v42 offset:4
    ds_read_b32 v199, v43 offset:4
    s_add_u32 s28, s28, 1
    s_cmp_lt_u32 s28, s27
    v_pk_fma_f32 v[54:55], v[54:55], v[70:71], v[54:55]
    v_pk_fma_f32 v[54:55], v[86:87], v[56:57], v[54:55]
    v_pk_fma_f32 v[56:57], v[56:57], v[70:71], v[56:57]
    v_pk_fma_f32 v[54:55], v[54:55], v[72:73], v[54:55]
    v_pk_fma_f32 v[54:55], v[88:89], v[56:57], v[54:55]
    v_pk_fma_f32 v[56:57], v[56:57], v[72:73], v[56:57]
    v_pk_fma_f32 v[54:55], v[54:55], v[74:75], v[54:55]
    v_pk_fma_f32 v[54:55], v[90:91], v[56:57], v[54:55]
    v_pk_fma_f32 v[56:57], v[56:57], v[74:75], v[56:57]
    v_pk_fma_f32 v[54:55], v[54:55], v[76:77], v[54:55]
    v_pk_fma_f32 v[54:55], v[92:93], v[56:57], v[54:55]
    v_pk_fma_f32 v[56:57], v[56:57], v[76:77], v[56:57]
    v_pk_fma_f32 v[54:55], v[54:55], v[78:79], v[54:55]
    v_pk_fma_f32 v[54:55], v[94:95], v[56:57], v[54:55]
    v_pk_fma_f32 v[56:57], v[56:57], v[78:79], v[56:57]
    s_setprio 2
    s_cbranch_scc0 K2F_EXIT1
    s_add_u32 m0, s29, 0
    s_add_u32 s38, s28, 1
    s_cmp_lt_u32 s38, s27
    s_cselect_b32 s6, 25000, 0
    s_waitcnt lgkmcnt(9)
    buffer_load_dwordx4 v[240:241], s[4:7], 0 idxen offen lds
    s_add_u32 m0, s29, 1024
    s_nop 0
    buffer_load_dwordx4 v[242:243], s[4:7], 0 idxen offen lds
    s_add_u32 m0, s29, 2048
    s_nop 0
    buffer_load_dwordx4 v[244:245], s[4:7], 0 idxen offen lds
    s_add_u32 m0, s29, 3072
    s_nop 0
    buffer_load_dwordx4 v[246:247], s[4:7], 0 idxen offen lds
    v_mfma_f32_32x32x16_bf16 v[64:79], v[200:203], v[128:131], 0
    v_rcp_f32 v58, v56
    v_rcp_f32 v59, v57
    v_max3_f32 v37, v56, v57, v37
    s_waitcnt lgkmcnt(5)
    v_fma_f32 v50, v54, v58, v46
    v_mfma_f32_32x32x16_bf16 v[64:79], v[204:207], v[132:135], v[64:79]
    s_waitcnt lgkmcnt(4)
    v_fma_f32 v52, v55, v59, v48
    v_exp_f32 v96, v96
    v_exp_f32 v97, v97
    v_mfma_f32_32x32x16_bf16 v[64:79], v[208:211], v[136:139], v[64:79]
    v_exp_f32 v98, v98
    v_exp_f32 v99, v99
    v_exp_f32 v100, v100
    v_mfma_f32_32x32x16_bf16 v[64:79], v[212:215], v[140:143], v[64:79]
    v_exp_f32 v101, v101
    v_exp_f32 v102, v102
    v_exp_f32 v103, v103
    s_waitcnt lgkmcnt(2)
    v_mfma_f32_32x32x16_bf16 v[64:79], v[232:235], v[192:195], v[64:79]
    v_exp_f32 v104, v104
    v_exp_f32 v105, v105
    v_add_f32 v56, 1.0, v96
    v_add_f32 v57, 1.0, v97
    v_mfma_f32_32x32x16_bf16 v[80:95], v[200:203], v[160:163], 0
    s_setprio 1
    v_exp_f32 v106, v106
    v_exp_f32 v107, v107
    v_fma_f32 v54, v112, v98, v112
    v_fma_f32 v55, v113, v99, v113
    v_mfma_f32_32x32x16_bf16 v[80:95], v[204:207], v[164:167], v[80:95]
    v_exp_f32 v108, v108
    v_exp_f32 v109, v109
    v_fmac_f32 v54, v114, v56
    v_fmac_f32 v55, v115, v57
    v_mfma_f32_32x32x16_bf16 v[80:95], v[208:211], v[168:171], v[80:95]
    v_exp_f32 v110, v110
    v_exp_f32 v111, v111
    v_fmac_f32 v56, v56, v98
    v_fmac_f32 v57, v57, v99
    v_mfma_f32_32x32x16_bf16 v[80:95], v[212:215], v[172:175], v[80:95]
    v_add_u32 v38, 128, v38
    v_add_u32 v39, 64, v39
    v_add_u32 v40, 64, v40
    v_fmac_f32 v54, v54, v100
    v_fmac_f32 v55, v55, v101
    v_fmac_f32 v54, v116, v56
    v_fmac_f32 v55, v117, v57
    v_fmac_f32 v56, v56, v100
    v_fmac_f32 v57, v57, v101
    s_setprio 3
    ds_read_u16 v240, v39 offset:64
    ds_read_u16 v242, v39 offset:1088
    ds_read_u16 v244, v39 offset:2112
    ds_read_u16 v246, v39 offset:3136
    v_pk_fma_f32 v[54:55], v[54:55], v[102:103], v[54:55]
    v_pk_fma_f32 v[54:55], v[118:119], v[56:57], v[54:55]
    v_pk_fma_f32 v[56:57], v[56:57], v[102:103], v[56:57]
    v_pk_fma_f32 v[54:55], v[54:55], v[104:105], v[54:55]
    v_pk_fma_f32 v[54:55], v[120:121], v[56:57], v[54:55]
    v_pk_fma_f32 v[56:57], v[56:57], v[104:105], v[56:57]
    v_pk_fma_f32 v[54:55], v[54:55], v[106:107], v[54:55]
    v_pk_fma_f32 v[54:55], v[122:123], v[56:57], v[54:55]
    v_pk_fma_f32 v[56:57], v[56:57], v[106:107], v[56:57]
    v_pk_fma_f32 v[54:55], v[54:55], v[108:109], v[54:55]
    v_pk_fma_f32 v[54:55], v[124:125], v[56:57], v[54:55]
    v_pk_fma_f32 v[56:57], v[56:57], v[108:109], v[56:57]
    v_pk_fma_f32 v[54:55], v[54:55], v[110:111], v[54:55]
    v_pk_fma_f32 v[54:55], v[126:127], v[56:57], v[54:55]
    v_pk_fma_f32 v[56:57], v[56:57], v[110:111], v[56:57]
    s_setprio 2
    s_branch K2F_LOOP
K2F_EXIT1:
    v_mov_b32 v42, v44
    v_mov_b32 v43, v45
K2F_EXIT0:
    v_rcp_f32 v58, v56
    v_rcp_f32 v59, v57
    v_max3_f32 v37, v56, v57, v37
    v_exp_f32 v96, v96
    v_exp_f32 v97, v97
    v_exp_f32 v98, v98
    v_exp_f32 v99, v99
    s_waitcnt lgkmcnt(0)
    v_fma_f32 v50, v54, v58, v46
    v_fma_f32 v52, v55, v59, v48
    v_exp_f32 v100, v100
    v_exp_f32 v101, v101
    v_exp_f32 v102, v102
    v_exp_f32 v103, v103
    v_exp_f32 v104, v104
    v_exp_f32 v105, v105
    v_exp_f32 v106, v106
    v_exp_f32 v107, v107
    v_exp_f32 v108, v108
    v_exp_f32 v109, v109
    v_exp_f32 v110, v110
    v_exp_f32 v111, v111
    v_pk_add_f32 v[56:57], v[96:97], s[32:33]
    v_pk_fma_f32 v[54:55], v[112:113], v[98:99], v[112:113]
    v_pk_fma_f32 v[54:55], v[114:115], v[56:57], v[54:55]
    v_pk_fma_f32 v[56:57], v[56:57], v[98:99], v[56:57]
    v_pk_fma_f32 v[54:55], v[54:55], v[100:101], v[54:55]
    v_pk_fma_f32 v[54:55], v[116:117], v[56:57], v[54:55]
    v_pk_fma_f32 v[56:57], v[56:57], v[100:101], v[56:57]
    v_pk_fma_f32 v[54:55], v[54:55], v[102:103], v[54:55]
    v_pk_fma_f32 v[54:55], v[118:119], v[56:57], v[54:55]
    v_pk_fma_f32 v[56:57], v[56:57], v[102:103], v[56:57]
    v_pk_fma_f32 v[54:55], v[54:55], v[104:105], v[54:55]
    v_pk_fma_f32 v[54:55], v[120:121], v[56:57], v[54:55]
    v_pk_fma_f32 v[56:57], v[56:57], v[104:105], v[56:57]
    v_pk_fma_f32 v[54:55], v[54:55], v[106:107], v[54:55]
    v_pk_fma_f32 v[54:55], v[122:123], v[56:57], v[54:55]
    v_pk_fma_f32 v[56:57], v[56:57], v[106:107], v[56:57]
    v_pk_fma_f32 v[54:55], v[54:55], v[108:109], v[54:55]
    v_pk_fma_f32 v[54:55], v[124:125], v[56:57], v[54:55]
    v_pk_fma_f32 v[56:57], v[56:57], v[108:109], v[56:57]
    v_pk_fma_f32 v[54:55], v[54:55], v[110:111], v[54:55]
    v_pk_fma_f32 v[54:55], v[126:127], v[56:57], v[54:55]
    v_pk_fma_f32 v[56:57], v[56:57], v[110:111], v[56:57]
    v_rcp_f32 v58, v56
    v_rcp_f32 v59, v57
    v_max3_f32 v37, v56, v57, v37
    v_fma_f32 v51, v54, v58, v47
    v_fma_f32 v53, v55, v59, v49
    ds_write_b64 v42, v[50:51] offset:33536
    ds_write_b64 v43, v[52:53] offset:33536
K2_DONE:
    s_setprio 0

    v_cmp_lt_f32 vcc, v7, v37
    s_mov_b64 exec, vcc
    ds_write_b32 v1, v15 offset:4
    s_mov_b64 exec, -1
    s_waitcnt vmcnt(0) lgkmcnt(0)
    s_barrier

    ds_read_b64 v[8:9], v6
    ds_read_b64 v[10:11], v6 offset:512
    ds_read_b32 v7, v1
    ds_read_b128 v[16:19], v5
    ds_read_b128 v[20:23], v5 offset:16
    ds_read_b128 v[24:27], v5 offset:16384
    ds_read_b128 v[28:31], v5 offset:16400
    s_waitcnt lgkmcnt(4)
    v_readfirstlane_b32 s44, v7
K2_MRG:
    v_cmp_lt_u32 s[38:39], v8, v9
    v_cmp_lt_u32 s[40:41], v10, v11
    v_lshl_add_u32 v14, v8, 8, v4
    v_lshl_add_u32 v7, v10, 8, v4
    s_or_b64 vcc, s[38:39], s[40:41]
    s_cbranch_scc0 K2_MRGD
    s_mov_b64 exec, s[38:39]
    ds_read_b128 v[68:71], v14
    ds_read_b128 v[72:75], v14 offset:16
    v_add_u32 v8, 1, v8
    s_mov_b64 exec, s[40:41]
    ds_read_b128 v[76:79], v7
    ds_read_b128 v[80:83], v7 offset:16
    v_add_u32 v10, 1, v10
    s_mov_b64 exec, s[38:39]
    s_waitcnt lgkmcnt(2)

    v_pk_add_f32 v[16:17], v[16:17], v[68:69]
    v_pk_add_f32 v[18:19], v[18:19], v[70:71]
    v_pk_add_f32 v[20:21], v[20:21], v[72:73]
    v_pk_add_f32 v[22:23], v[22:23], v[74:75]
    s_mov_b64 exec, s[40:41]
    s_waitcnt lgkmcnt(0)

    v_pk_add_f32 v[24:25], v[24:25], v[76:77]
    v_pk_add_f32 v[26:27], v[26:27], v[78:79]
    v_pk_add_f32 v[28:29], v[28:29], v[80:81]
    v_pk_add_f32 v[30:31], v[30:31], v[82:83]
    s_mov_b64 exec, -1
    s_branch K2_MRG
K2_MRGD:
    s_cmp_lg_u32 s44, 0
    s_waitcnt lgkmcnt(0)
    s_cbranch_scc1 K2_NEXT

    v_pk_mul_f32 v[68:69], v[16:17], s[30:31]
    v_pk_mul_f32 v[70:71], v[18:19], s[30:31]
    v_pk_mul_f32 v[72:73], v[20:21], s[30:31]
    v_pk_mul_f32 v[74:75], v[22:23], s[30:31]
    v_exp_f32 v68, v68
    v_exp_f32 v69, v69
    v_exp_f32 v70, v70
    v_exp_f32 v71, v71
    v_exp_f32 v72, v72
    v_exp_f32 v73, v73
    v_exp_f32 v74, v74
    v_exp_f32 v75, v75
    v_pk_fma_f32 v[32:33], v[16:17], v[34:35], v[32:33]
    v_pk_fma_f32 v[32:33], v[18:19], v[34:35], v[32:33]
    v_pk_fma_f32 v[32:33], v[20:21], v[34:35], v[32:33]
    v_pk_fma_f32 v[32:33], v[22:23], v[34:35], v[32:33]
    v_pk_add_f32 v[68:69], v[68:69], s[32:33]
    v_pk_add_f32 v[70:71], v[70:71], s[32:33]
    v_pk_add_f32 v[72:73], v[72:73], s[32:33]
    v_pk_add_f32 v[74:75], v[74:75], s[32:33]
    v_rcp_f32 v68, v68
    v_rcp_f32 v69, v69
    v_rcp_f32 v70, v70
    v_rcp_f32 v71, v71
    v_rcp_f32 v72, v72
    v_rcp_f32 v73, v73
    v_rcp_f32 v74, v74
    v_rcp_f32 v75, v75
    s_nop 0
    v_pk_mul_f32 v[68:69], v[68:69], v[16:17]
    v_pk_mul_f32 v[70:71], v[70:71], v[18:19]
    v_pk_mul_f32 v[72:73], v[72:73], v[20:21]
    v_pk_mul_f32 v[74:75], v[74:75], v[22:23]
    v_cvt_pk_bf16_f32 v16, v68, v69
    v_cvt_pk_bf16_f32 v17, v70, v71
    v_cvt_pk_bf16_f32 v18, v72, v73
    v_cvt_pk_bf16_f32 v19, v74, v75
    buffer_store_dwordx4 v[16:19], v[12:13], s[12:15], 0 idxen offen sc1
    s_mov_b64 exec, s[42:43]
    s_cbranch_execz K2_OUT2
    v_add_u32 v10, 16384, v12
    v_mov_b32 v11, v13

    v_pk_mul_f32 v[76:77], v[24:25], s[30:31]
    v_pk_mul_f32 v[78:79], v[26:27], s[30:31]
    v_pk_mul_f32 v[80:81], v[28:29], s[30:31]
    v_pk_mul_f32 v[82:83], v[30:31], s[30:31]
    v_exp_f32 v76, v76
    v_exp_f32 v77, v77
    v_exp_f32 v78, v78
    v_exp_f32 v79, v79
    v_exp_f32 v80, v80
    v_exp_f32 v81, v81
    v_exp_f32 v82, v82
    v_exp_f32 v83, v83
    v_pk_fma_f32 v[32:33], v[24:25], v[34:35], v[32:33]
    v_pk_fma_f32 v[32:33], v[26:27], v[34:35], v[32:33]
    v_pk_fma_f32 v[32:33], v[28:29], v[34:35], v[32:33]
    v_pk_fma_f32 v[32:33], v[30:31], v[34:35], v[32:33]
    v_pk_add_f32 v[76:77], v[76:77], s[32:33]
    v_pk_add_f32 v[78:79], v[78:79], s[32:33]
    v_pk_add_f32 v[80:81], v[80:81], s[32:33]
    v_pk_add_f32 v[82:83], v[82:83], s[32:33]
    v_rcp_f32 v76, v76
    v_rcp_f32 v77, v77
    v_rcp_f32 v78, v78
    v_rcp_f32 v79, v79
    v_rcp_f32 v80, v80
    v_rcp_f32 v81, v81
    v_rcp_f32 v82, v82
    v_rcp_f32 v83, v83
    s_nop 0
    v_pk_mul_f32 v[76:77], v[76:77], v[24:25]
    v_pk_mul_f32 v[78:79], v[78:79], v[26:27]
    v_pk_mul_f32 v[80:81], v[80:81], v[28:29]
    v_pk_mul_f32 v[82:83], v[82:83], v[30:31]
    v_cvt_pk_bf16_f32 v24, v76, v77
    v_cvt_pk_bf16_f32 v25, v78, v79
    v_cvt_pk_bf16_f32 v26, v80, v81
    v_cvt_pk_bf16_f32 v27, v82, v83
    buffer_store_dwordx4 v[24:27], v[10:11], s[12:15], 0 idxen offen sc1
K2_OUT2:
    s_mov_b64 exec, -1
    v_cmp_u_f32 vcc, v32, v33
    s_cmp_lg_u32 s24, 0
    s_cbranch_scc1 K2_FIN
    s_mov_b64 exec, vcc
    ds_write_b32 v1, v15 offset:4
    s_mov_b64 exec, -1
    s_waitcnt lgkmcnt(0)
    s_barrier
    ds_read_b32 v7, v1 offset:4
    s_waitcnt lgkmcnt(0)
    v_readfirstlane_b32 s38, v7
    s_cmp_lg_u32 s38, 0
    s_cbranch_scc1 K2_REDO
K2_FIN:

K2_END:
    s_endpgm
K2_NP1B:
    s_waitcnt vmcnt(0)
    s_branch K2_FRAG
K2_CAP:
    s_mov_b32 s26, 8
    s_waitcnt vmcnt(0) lgkmcnt(0)
    s_barrier
    s_branch K2_ROUND
K2_NEXT:
    ds_write_b128 v5, v[16:19]
    ds_write_b128 v5, v[20:23] offset:16
    s_mov_b64 exec, s[42:43]
    ds_write_b128 v5, v[24:27] offset:16384
    ds_write_b128 v5, v[28:31] offset:16400
    s_mov_b64 exec, -1
    s_add_u32 s25, s25, s26
    s_waitcnt lgkmcnt(0)
    s_barrier
    s_branch K2_ROUND
K2_REDO:
    s_load_dwordx16 s[48:63], s[0:1], 0
    s_load_dwordx4 s[64:67], s[0:1], 64
    s_mov_b32 s24, 1
    s_waitcnt vmcnt(0) lgkmcnt(0)
    s_barrier
    s_branch K2_START
K2S_PRE:
    s_nop 7
K2S_LOOP:

    ds_read_u16 v252, v40 offset:32
    ds_read_u16 v253, v40 offset:1056
    v_mfma_f32_32x32x16_bf16 v[96:111], v[200:203], v[144:147], 0
    v_add_f32 v51, v54, v47
    v_add_f32 v53, v55, v49
    v_mul_f32 v64, s30, v64
    v_mul_f32 v65, s30, v65
    v_mul_f32 v66, s30, v66
    v_mul_f32 v67, s30, v67
    v_mul_f32 v68, s30, v68
    v_mfma_f32_32x32x16_bf16 v[96:111], v[204:207], v[148:151], v[96:111]
    v_mul_f32 v69, s30, v69
    v_mul_f32 v70, s30, v70
    v_mul_f32 v71, s30, v71
    v_mul_f32 v72, s30, v72
    v_mul_f32 v73, s30, v73
    s_waitcnt vmcnt(0)
    ds_read_b128 v[216:219], v248
    ds_read_b128 v[220:223], v249
    ds_read_b128 v[224:227], v250
    ds_read_b128 v[228:231], v251
    ds_read_b64 v[236:237], v38 offset:64
    ds_write_b64 v44, v[50:51] offset:33536
    ds_write_b64 v45, v[52:53] offset:33536
    v_mfma_f32_32x32x16_bf16 v[96:111], v[208:211], v[152:155], v[96:111]
    v_mul_f32 v74, s30, v74
    v_mul_f32 v75, s30, v75
    v_mul_f32 v76, s30, v76
    v_mul_f32 v77, s30, v77
    v_mul_f32 v78, s30, v78
    v_mfma_f32_32x32x16_bf16 v[96:111], v[212:215], v[156:159], v[96:111]
    v_mul_f32 v79, s30, v79
    v_exp_f32 v64, v64
    v_exp_f32 v65, v65
    v_exp_f32 v66, v66
    v_exp_f32 v67, v67
    s_waitcnt lgkmcnt(13)
    v_mfma_f32_32x32x16_bf16 v[96:111], v[232:235], v[196:199], v[96:111]
    s_waitcnt lgkmcnt(8)
    v_add_u32 v44, v252, v41
    s_waitcnt lgkmcnt(7)
    v_add_u32 v45, v253, v41
    v_exp_f32 v68, v68
    v_exp_f32 v69, v69
    v_exp_f32 v70, v70
    v_exp_f32 v71, v71
    v_exp_f32 v72, v72
    v_mfma_f32_32x32x16_bf16 v[112:127], v[200:203], v[176:179], 0
    v_exp_f32 v73, v73
    v_exp_f32 v74, v74
    v_exp_f32 v75, v75
    v_exp_f32 v76, v76
    v_exp_f32 v77, v77
    v_mfma_f32_32x32x16_bf16 v[112:127], v[204:207], v[180:183], v[112:127]
    v_exp_f32 v78, v78
    v_exp_f32 v79, v79
    v_add_f32 v64, 1.0, v64
    v_add_f32 v65, 1.0, v65
    v_add_f32 v66, 1.0, v66
    v_mfma_f32_32x32x16_bf16 v[112:127], v[208:211], v[184:187], v[112:127]
    v_add_f32 v67, 1.0, v67
    v_add_f32 v68, 1.0, v68
    v_add_f32 v69, 1.0, v69
    v_add_f32 v70, 1.0, v70
    v_add_f32 v71, 1.0, v71
    v_mfma_f32_32x32x16_bf16 v[112:127], v[212:215], v[188:191], v[112:127]
    v_add_f32 v72, 1.0, v72
    v_add_f32 v73, 1.0, v73
    v_add_f32 v74, 1.0, v74
    v_add_f32 v75, 1.0, v75
    v_add_f32 v76, 1.0, v76
    ds_read_b64 v[46:47], v42 offset:33536
    ds_read_b64 v[48:49], v43 offset:33536
    ds_read_b32 v194, v44 offset:0
    ds_read_b32 v195, v45 offset:0
    ds_read_b32 v198, v44 offset:4
    ds_read_b32 v199, v45 offset:4
    v_add_f32 v77, 1.0, v77
    v_add_f32 v78, 1.0, v78
    v_add_f32 v79, 1.0, v79
    v_rcp_f32 v64, v64
    v_rcp_f32 v65, v65
    v_rcp_f32 v66, v66
    v_rcp_f32 v67, v67
    v_rcp_f32 v68, v68
    v_rcp_f32 v69, v69
    v_rcp_f32 v70, v70
    v_rcp_f32 v71, v71
    v_rcp_f32 v72, v72
    v_rcp_f32 v73, v73
    v_rcp_f32 v74, v74
    v_rcp_f32 v75, v75
    v_rcp_f32 v76, v76
    v_rcp_f32 v77, v77
    v_rcp_f32 v78, v78
    v_rcp_f32 v79, v79
    v_mul_f32 v54, v80, v64
    v_mul_f32 v55, v81, v65
    v_fmac_f32 v54, v82, v66
    v_fmac_f32 v55, v83, v67
    v_fmac_f32 v54, v84, v68
    v_fmac_f32 v55, v85, v69
    v_fmac_f32 v54, v86, v70
    v_fmac_f32 v55, v87, v71
    v_fmac_f32 v54, v88, v72
    v_fmac_f32 v55, v89, v73
    v_fmac_f32 v54, v90, v74
    v_fmac_f32 v55, v91, v75
    v_fmac_f32 v54, v92, v76
    v_fmac_f32 v55, v93, v77
    v_fmac_f32 v54, v94, v78
    v_fmac_f32 v55, v95, v79
    s_add_u32 m0, s29, 0
    s_add_u32 s38, s28, 2
    s_cmp_lt_u32 s38, s27
    s_cselect_b32 s6, 25000, 0
    s_waitcnt lgkmcnt(9)
    buffer_load_dwordx4 v[240:241], s[4:7], 0 idxen offen lds
    s_add_u32 m0, s29, 1024
    s_nop 0
    buffer_load_dwordx4 v[242:243], s[4:7], 0 idxen offen lds
    s_add_u32 m0, s29, 2048
    s_nop 0
    buffer_load_dwordx4 v[244:245], s[4:7], 0 idxen offen lds
    s_add_u32 m0, s29, 3072
    s_nop 0
    buffer_load_dwordx4 v[246:247], s[4:7], 0 idxen offen lds
    v_mfma_f32_32x32x16_bf16 v[64:79], v[216:219], v[128:131], 0
    s_waitcnt lgkmcnt(5)
    v_add_f32 v50, v54, v46
    s_waitcnt lgkmcnt(4)
    v_add_f32 v52, v55, v48
    v_mul_f32 v96, s30, v96
    v_mul_f32 v97, s30, v97
    v_mul_f32 v98, s30, v98
    v_mul_f32 v99, s30, v99
    v_mul_f32 v100, s30, v100
    v_mfma_f32_32x32x16_bf16 v[64:79], v[220:223], v[132:135], v[64:79]
    v_mul_f32 v101, s30, v101
    v_mul_f32 v102, s30, v102
    v_mul_f32 v103, s30, v103
    v_mul_f32 v104, s30, v104
    v_mul_f32 v105, s30, v105
    v_mfma_f32_32x32x16_bf16 v[64:79], v[224:227], v[136:139], v[64:79]
    v_mul_f32 v106, s30, v106
    v_mul_f32 v107, s30, v107
    v_mul_f32 v108, s30, v108
    v_mul_f32 v109, s30, v109
    v_mul_f32 v110, s30, v110
    v_mfma_f32_32x32x16_bf16 v[64:79], v[228:231], v[140:143], v[64:79]
    v_mul_f32 v111, s30, v111
    v_exp_f32 v96, v96
    v_exp_f32 v97, v97
    v_exp_f32 v98, v98
    v_exp_f32 v99, v99
    s_waitcnt lgkmcnt(2)
    v_mfma_f32_32x32x16_bf16 v[64:79], v[236:239], v[192:195], v[64:79]
    v_exp_f32 v100, v100
    v_exp_f32 v101, v101
    v_exp_f32 v102, v102
    v_exp_f32 v103, v103
    v_exp_f32 v104, v104
    v_mfma_f32_32x32x16_bf16 v[80:95], v[216:219], v[160:163], 0
    v_exp_f32 v105, v105
    v_exp_f32 v106, v106
    v_exp_f32 v107, v107
    v_exp_f32 v108, v108
    v_exp_f32 v109, v109
    v_mfma_f32_32x32x16_bf16 v[80:95], v[220:223], v[164:167], v[80:95]
    v_exp_f32 v110, v110
    v_exp_f32 v111, v111
    v_add_f32 v96, 1.0, v96
    v_add_f32 v97, 1.0, v97
    v_add_f32 v98, 1.0, v98
    v_mfma_f32_32x32x16_bf16 v[80:95], v[224:227], v[168:171], v[80:95]
    v_add_f32 v99, 1.0, v99
    v_add_f32 v100, 1.0, v100
    v_add_f32 v101, 1.0, v101
    v_add_f32 v102, 1.0, v102
    v_add_f32 v103, 1.0, v103
    v_mfma_f32_32x32x16_bf16 v[80:95], v[228:231], v[172:175], v[80:95]
    v_add_f32 v104, 1.0, v104
    v_add_f32 v105, 1.0, v105
    v_add_f32 v106, 1.0, v106
    v_add_f32 v107, 1.0, v107
    v_add_f32 v108, 1.0, v108
    ds_read_u16 v240, v39 offset:96
    ds_read_u16 v242, v39 offset:1120
    ds_read_u16 v244, v39 offset:2144
    ds_read_u16 v246, v39 offset:3168
    s_add_u32 s28, s28, 1
    s_cmp_lt_u32 s28, s27
    v_add_f32 v109, 1.0, v109
    v_add_f32 v110, 1.0, v110
    v_add_f32 v111, 1.0, v111
    v_rcp_f32 v96, v96
    v_rcp_f32 v97, v97
    v_rcp_f32 v98, v98
    v_rcp_f32 v99, v99
    v_rcp_f32 v100, v100
    v_rcp_f32 v101, v101
    v_rcp_f32 v102, v102
    v_rcp_f32 v103, v103
    v_rcp_f32 v104, v104
    v_rcp_f32 v105, v105
    v_rcp_f32 v106, v106
    v_rcp_f32 v107, v107
    v_rcp_f32 v108, v108
    v_rcp_f32 v109, v109
    v_rcp_f32 v110, v110
    v_rcp_f32 v111, v111
    v_mul_f32 v54, v112, v96
    v_mul_f32 v55, v113, v97
    v_fmac_f32 v54, v114, v98
    v_fmac_f32 v55, v115, v99
    v_fmac_f32 v54, v116, v100
    v_fmac_f32 v55, v117, v101
    v_fmac_f32 v54, v118, v102
    v_fmac_f32 v55, v119, v103
    v_fmac_f32 v54, v120, v104
    v_fmac_f32 v55, v121, v105
    v_fmac_f32 v54, v122, v106
    v_fmac_f32 v55, v123, v107
    v_fmac_f32 v54, v124, v108
    v_fmac_f32 v55, v125, v109
    v_fmac_f32 v54, v126, v110
    v_fmac_f32 v55, v127, v111
    s_cbranch_scc0 K2S_EXIT0
    ds_read_u16 v252, v40 offset:64
    ds_read_u16 v253, v40 offset:1088
    v_mfma_f32_32x32x16_bf16 v[96:111], v[216:219], v[144:147], 0
    v_add_f32 v51, v54, v47
    v_add_f32 v53, v55, v49
    v_mul_f32 v64, s30, v64
    v_mul_f32 v65, s30, v65
    v_mul_f32 v66, s30, v66
    v_mul_f32 v67, s30, v67
    v_mul_f32 v68, s30, v68
    v_mfma_f32_32x32x16_bf16 v[96:111], v[220:223], v[148:151], v[96:111]
    v_mul_f32 v69, s30, v69
    v_mul_f32 v70, s30, v70
    v_mul_f32 v71, s30, v71
    v_mul_f32 v72, s30, v72
    v_mul_f32 v73, s30, v73
    s_waitcnt vmcnt(0)
    ds_read_b128 v[200:203], v248
    ds_read_b128 v[204:207], v249
    ds_read_b128 v[208:211], v250
    ds_read_b128 v[212:215], v251
    ds_read_b64 v[232:233], v38 offset:128
    ds_write_b64 v42, v[50:51] offset:33536
    ds_write_b64 v43, v[52:53] offset:33536
    v_mfma_f32_32x32x16_bf16 v[96:111], v[224:227], v[152:155], v[96:111]
    v_mul_f32 v74, s30, v74
    v_mul_f32 v75, s30, v75
    v_mul_f32 v76, s30, v76
    v_mul_f32 v77, s30, v77
    v_mul_f32 v78, s30, v78
    v_mfma_f32_32x32x16_bf16 v[96:111], v[228:231], v[156:159], v[96:111]
    v_mul_f32 v79, s30, v79
    v_exp_f32 v64, v64
    v_exp_f32 v65, v65
    v_exp_f32 v66, v66
    v_exp_f32 v67, v67
    s_waitcnt lgkmcnt(13)
    v_mfma_f32_32x32x16_bf16 v[96:111], v[236:239], v[196:199], v[96:111]
    s_waitcnt lgkmcnt(8)
    v_add_u32 v42, v252, v41
    s_waitcnt lgkmcnt(7)
    v_add_u32 v43, v253, v41
    v_exp_f32 v68, v68
    v_exp_f32 v69, v69
    v_exp_f32 v70, v70
    v_exp_f32 v71, v71
    v_exp_f32 v72, v72
    v_mfma_f32_32x32x16_bf16 v[112:127], v[216:219], v[176:179], 0
    v_exp_f32 v73, v73
    v_exp_f32 v74, v74
    v_exp_f32 v75, v75
    v_exp_f32 v76, v76
    v_exp_f32 v77, v77
    v_mfma_f32_32x32x16_bf16 v[112:127], v[220:223], v[180:183], v[112:127]
    v_exp_f32 v78, v78
    v_exp_f32 v79, v79
    v_add_f32 v64, 1.0, v64
    v_add_f32 v65, 1.0, v65
    v_add_f32 v66, 1.0, v66
    v_mfma_f32_32x32x16_bf16 v[112:127], v[224:227], v[184:187], v[112:127]
    v_add_f32 v67, 1.0, v67
    v_add_f32 v68, 1.0, v68
    v_add_f32 v69, 1.0, v69
    v_add_f32 v70, 1.0, v70
    v_add_f32 v71, 1.0, v71
    v_mfma_f32_32x32x16_bf16 v[112:127], v[228:231], v[188:191], v[112:127]
    v_add_f32 v72, 1.0, v72
    v_add_f32 v73, 1.0, v73
    v_add_f32 v74, 1.0, v74
    v_add_f32 v75, 1.0, v75
    v_add_f32 v76, 1.0, v76
    ds_read_b64 v[46:47], v44 offset:33536
    ds_read_b64 v[48:49], v45 offset:33536
    ds_read_b32 v194, v42 offset:0
    ds_read_b32 v195, v43 offset:0
    ds_read_b32 v198, v42 offset:4
    ds_read_b32 v199, v43 offset:4
    v_add_f32 v77, 1.0, v77
    v_add_f32 v78, 1.0, v78
    v_add_f32 v79, 1.0, v79
    v_rcp_f32 v64, v64
    v_rcp_f32 v65, v65
    v_rcp_f32 v66, v66
    v_rcp_f32 v67, v67
    v_rcp_f32 v68, v68
    v_rcp_f32 v69, v69
    v_rcp_f32 v70, v70
    v_rcp_f32 v71, v71
    v_rcp_f32 v72, v72
    v_rcp_f32 v73, v73
    v_rcp_f32 v74, v74
    v_rcp_f32 v75, v75
    v_rcp_f32 v76, v76
    v_rcp_f32 v77, v77
    v_rcp_f32 v78, v78
    v_rcp_f32 v79, v79
    v_mul_f32 v54, v80, v64
    v_mul_f32 v55, v81, v65
    v_fmac_f32 v54, v82, v66
    v_fmac_f32 v55, v83, v67
    v_fmac_f32 v54, v84, v68
    v_fmac_f32 v55, v85, v69
    v_fmac_f32 v54, v86, v70
    v_fmac_f32 v55, v87, v71
    v_fmac_f32 v54, v88, v72
    v_fmac_f32 v55, v89, v73
    v_fmac_f32 v54, v90, v74
    v_fmac_f32 v55, v91, v75
    v_fmac_f32 v54, v92, v76
    v_fmac_f32 v55, v93, v77
    v_fmac_f32 v54, v94, v78
    v_fmac_f32 v55, v95, v79
    s_add_u32 m0, s29, 0
    s_add_u32 s38, s28, 2
    s_cmp_lt_u32 s38, s27
    s_cselect_b32 s6, 25000, 0
    s_waitcnt lgkmcnt(9)
    buffer_load_dwordx4 v[240:241], s[4:7], 0 idxen offen lds
    s_add_u32 m0, s29, 1024
    s_nop 0
    buffer_load_dwordx4 v[242:243], s[4:7], 0 idxen offen lds
    s_add_u32 m0, s29, 2048
    s_nop 0
    buffer_load_dwordx4 v[244:245], s[4:7], 0 idxen offen lds
    s_add_u32 m0, s29, 3072
    s_nop 0
    buffer_load_dwordx4 v[246:247], s[4:7], 0 idxen offen lds
    v_mfma_f32_32x32x16_bf16 v[64:79], v[200:203], v[128:131], 0
    s_waitcnt lgkmcnt(5)
    v_add_f32 v50, v54, v46
    s_waitcnt lgkmcnt(4)
    v_add_f32 v52, v55, v48
    v_mul_f32 v96, s30, v96
    v_mul_f32 v97, s30, v97
    v_mul_f32 v98, s30, v98
    v_mul_f32 v99, s30, v99
    v_mul_f32 v100, s30, v100
    v_mfma_f32_32x32x16_bf16 v[64:79], v[204:207], v[132:135], v[64:79]
    v_mul_f32 v101, s30, v101
    v_mul_f32 v102, s30, v102
    v_mul_f32 v103, s30, v103
    v_mul_f32 v104, s30, v104
    v_mul_f32 v105, s30, v105
    v_mfma_f32_32x32x16_bf16 v[64:79], v[208:211], v[136:139], v[64:79]
    v_mul_f32 v106, s30, v106
    v_mul_f32 v107, s30, v107
    v_mul_f32 v108, s30, v108
    v_mul_f32 v109, s30, v109
    v_mul_f32 v110, s30, v110
    v_mfma_f32_32x32x16_bf16 v[64:79], v[212:215], v[140:143], v[64:79]
    v_mul_f32 v111, s30, v111
    v_exp_f32 v96, v96
    v_exp_f32 v97, v97
    v_exp_f32 v98, v98
    v_exp_f32 v99, v99
    s_waitcnt lgkmcnt(2)
    v_mfma_f32_32x32x16_bf16 v[64:79], v[232:235], v[192:195], v[64:79]
    v_exp_f32 v100, v100
    v_exp_f32 v101, v101
    v_exp_f32 v102, v102
    v_exp_f32 v103, v103
    v_exp_f32 v104, v104
    v_mfma_f32_32x32x16_bf16 v[80:95], v[200:203], v[160:163], 0
    v_exp_f32 v105, v105
    v_exp_f32 v106, v106
    v_exp_f32 v107, v107
    v_exp_f32 v108, v108
    v_exp_f32 v109, v109
    v_mfma_f32_32x32x16_bf16 v[80:95], v[204:207], v[164:167], v[80:95]
    v_exp_f32 v110, v110
    v_exp_f32 v111, v111
    v_add_f32 v96, 1.0, v96
    v_add_f32 v97, 1.0, v97
    v_add_f32 v98, 1.0, v98
    v_mfma_f32_32x32x16_bf16 v[80:95], v[208:211], v[168:171], v[80:95]
    v_add_f32 v99, 1.0, v99
    v_add_f32 v100, 1.0, v100
    v_add_f32 v101, 1.0, v101
    v_add_f32 v102, 1.0, v102
    v_add_f32 v103, 1.0, v103
    v_mfma_f32_32x32x16_bf16 v[80:95], v[212:215], v[172:175], v[80:95]
    v_add_u32 v38, 128, v38
    v_add_u32 v39, 64, v39
    v_add_u32 v40, 64, v40
    v_add_f32 v104, 1.0, v104
    v_add_f32 v105, 1.0, v105
    v_add_f32 v106, 1.0, v106
    v_add_f32 v107, 1.0, v107
    v_add_f32 v108, 1.0, v108
    ds_read_u16 v240, v39 offset:64
    ds_read_u16 v242, v39 offset:1088
    ds_read_u16 v244, v39 offset:2112
    ds_read_u16 v246, v39 offset:3136
    s_add_u32 s28, s28, 1
    s_cmp_lt_u32 s28, s27
    v_add_f32 v109, 1.0, v109
    v_add_f32 v110, 1.0, v110
    v_add_f32 v111, 1.0, v111
    v_rcp_f32 v96, v96
    v_rcp_f32 v97, v97
    v_rcp_f32 v98, v98
    v_rcp_f32 v99, v99
    v_rcp_f32 v100, v100
    v_rcp_f32 v101, v101
    v_rcp_f32 v102, v102
    v_rcp_f32 v103, v103
    v_rcp_f32 v104, v104
    v_rcp_f32 v105, v105
    v_rcp_f32 v106, v106
    v_rcp_f32 v107, v107
    v_rcp_f32 v108, v108
    v_rcp_f32 v109, v109
    v_rcp_f32 v110, v110
    v_rcp_f32 v111, v111
    v_mul_f32 v54, v112, v96
    v_mul_f32 v55, v113, v97
    v_fmac_f32 v54, v114, v98
    v_fmac_f32 v55, v115, v99
    v_fmac_f32 v54, v116, v100
    v_fmac_f32 v55, v117, v101
    v_fmac_f32 v54, v118, v102
    v_fmac_f32 v55, v119, v103
    v_fmac_f32 v54, v120, v104
    v_fmac_f32 v55, v121, v105
    v_fmac_f32 v54, v122, v106
    v_fmac_f32 v55, v123, v107
    v_fmac_f32 v54, v124, v108
    v_fmac_f32 v55, v125, v109
    v_fmac_f32 v54, v126, v110
    v_fmac_f32 v55, v127, v111
    s_cbranch_scc1 K2S_LOOP
    v_mov_b32 v42, v44
    v_mov_b32 v43, v45
K2S_EXIT0:
    v_add_f32 v51, v54, v47
    v_add_f32 v53, v55, v49
    ds_write_b64 v42, v[50:51] offset:33536
    ds_write_b64 v43, v[52:53] offset:33536
    s_branch K2_DONE
.section .rodata,"a"
.p2align 6
.amdhsa_kernel standalone__edge_featured_mpnn_egc__graph_kernel
  .amdhsa_next_free_vgpr 256
  .amdhsa_next_free_sgpr 102
  .amdhsa_accum_offset 256
  .amdhsa_group_segment_fixed_size 0
  .amdhsa_kernarg_size 80
  .amdhsa_user_sgpr_count 2
  .amdhsa_user_sgpr_kernarg_segment_ptr 1
  .amdhsa_system_sgpr_workgroup_id_x 1
.end_amdhsa_kernel
```
